```python
import torch

def _softmax(x, axis=-1):
    return torch.softmax(x, dim=axis)
def _gelu(x):
    return torch.nn.functional.gelu(x, approximate="tanh")
def _silu(x):
    return torch.nn.functional.silu(x)
def _sigmoid(x):
    return torch.sigmoid(x)
def _layernorm(x, axis=-1, eps=1e-5):
    m = x.mean(dim=axis, keepdim=True)
    v = x.var(dim=axis, keepdim=True, unbiased=False)
    return (x - m) / torch.sqrt(v + eps)
def _scatter_add(tgt, idx, src, axis=0):
    return tgt.clone().index_add_(axis, idx, src)
def _segment_sum(src, seg, n):
    out = torch.zeros((n,) + src.shape[1:], dtype=src.dtype)
    return out.index_add_(0, seg, src)
def _pad(x, pw):
    flat = tuple(v for pair in reversed(pw) for v in pair)
    return torch.nn.functional.pad(x, flat)

kernel_name = 'gated_mix__mha_block_cached__geglu_ffn__decode'

def setup_inputs():

    _w = (lambda a: (lambda t: t.to(torch.bfloat16) if t.is_floating_point() else t)(torch.as_tensor(a)))
    def _A_setup():
        B, Sq, D = 4, 1, 640
        H, Sk, Dh = 32, 4096, 192
        return {
            "x": _w((lambda *s: torch.randn(*s, dtype=torch.bfloat16) * 0.05)(B, Sq, D)),
            "k_cache": _w((lambda *s: torch.randn(*s, dtype=torch.bfloat16) * 6.4)(B, H, Sk, Dh)),
            "v_cache": _w((lambda *s: torch.randn(*s, dtype=torch.bfloat16) * 0.2)(B, H, Sk, Dh)),
            "wq": _w((lambda *s: torch.randn(*s, dtype=torch.bfloat16) * 6.4)(D, H * Dh) * (D ** -0.5)),
            "wo": _w((lambda *s: torch.randn(*s, dtype=torch.bfloat16) * 0.2)(H * Dh, D) * ((H * Dh) ** -0.5)),
        }
    _A_in = _A_setup()

    def _B_setup():
        B, S, D, F = 4, 1, 640, 1536
        return {
            "x": _w((lambda *s: torch.randn(*s, dtype=torch.bfloat16) * 0.05)(B, S, D)),
            "w_gate": _w((lambda *s: torch.randn(*s, dtype=torch.bfloat16) * 0.05)(D, F)),
            "w_up": _w((lambda *s: torch.randn(*s, dtype=torch.bfloat16) * 0.05)(D, F)),
            "w_down": _w((lambda *s: torch.randn(*s, dtype=torch.bfloat16) * 0.05)(F, D)),
        }
    _B_in = _B_setup()

    return {
        "A_x": _A_in["x"],
        "A_k_cache": _A_in["k_cache"],
        "A_v_cache": _A_in["v_cache"],
        "A_wq": _A_in["wq"],
        "A_wo": _A_in["wo"],
        "B_x": _B_in["x"],
        "B_w_gate": _B_in["w_gate"],
        "B_w_up": _B_in["w_up"],
        "B_w_down": _B_in["w_down"],
        "gate_w": _w((lambda *s: torch.randn(*s, dtype=torch.bfloat16) * 0.05)(640) * 16.0),
    }

def reference(A_x, A_k_cache, A_v_cache, A_wq, A_wo, B_x, B_w_gate, B_w_up, B_w_down, gate_w):
    def _A_ref(x, k_cache, v_cache, wq, wo):
        B, Sq, D = x.shape
        H, Dh = 32, 192
        q = (lambda x, *d: x.permute(*d))((x @ wq).reshape(B, Sq, H, Dh), 0, 2, 1, 3)
        scores = torch.einsum("bhqd,bhkd->bhqk", q, k_cache) * (Dh ** -0.5)
        p = _softmax(scores, axis=-1)
        o = torch.einsum("bhqk,bhkd->bhqd", p, v_cache)
        return (lambda x, *d: x.permute(*d))(o, 0, 2, 1, 3).reshape(B, Sq, H * Dh) @ wo

    def _B_ref(x, w_gate, w_up, w_down):
        return (_gelu(x @ w_gate) * (x @ w_up)) @ w_down

    x = A_x
    g = _sigmoid((x * gate_w).sum(-1, keepdims=True))
    a = _A_ref(x, A_k_cache, A_v_cache, A_wq, A_wo)
    b = _B_ref(x, B_w_gate, B_w_up, B_w_down)
    return g * a + (1 - g) * b
```

```asm
; @launch grid=(256,1,1) block=(512,1,1) lds=126976
.amdgcn_target "amdgcn-amd-amdhsa--gfx950"
.text
.globl gated_mix__mha_block_cached__geglu_ffn__decode_kernel
.p2align 8
.type gated_mix__mha_block_cached__geglu_ffn__decode_kernel,@function
gated_mix__mha_block_cached__geglu_ffn__decode_kernel:
  s_cmp_ge_u32 s2, 256
  s_cbranch_scc1 L_end
  s_load_dwordx16 s[4:19], s[0:1], 0
  s_load_dwordx8 s[20:27], s[0:1], 64
  s_load_dwordx2 s[28:29], s[0:1], 96
  v_lshrrev_b32 v1, 6, v0
  v_and_b32 v0, 63, v0
  v_readfirstlane_b32 s3, v1
  s_lshr_b32 s30, s2, 6
  s_lshl_b32 s30, s30, 3
  s_and_b32 s31, s2, 7
  s_add_u32 s30, s30, s31
  s_bfe_u32 s31, s2, 0x30003
  s_cmp_ge_u32 s3, 4
  s_cbranch_scc1 L_stream
  v_lshlrev_b32 v8, 2, v0
  v_add_u32 v8, 126720, v8
  v_mov_b32 v9, 0
  ds_write_b32 v8, v9
  v_bfe_u32 v4, v0, 3, 2
  v_lshrrev_b32 v5, 5, v0
  v_lshl_add_u32 v4, v5, 3, v4
  v_lshrrev_b32 v5, 3, v0
  v_and_b32 v5, 6, v5
  v_xor_b32 v5, v5, v0
  v_and_b32 v5, 7, v5
  v_lshlrev_b32 v5, 4, v5
  s_cmp_ge_u32 s31, 3
  s_cselect_b32 s60, 1, 0
  s_mul_i32 s62, s60, 30717
  s_add_u32 s61, s31, s62
  s_mul_i32 s62, s30, 3
  s_add_u32 s61, s61, s62
  s_mulk_i32 s60, 640
  s_cmp_lt_u32 s30, 24
  s_cselect_b32 s63, 20, 0
  s_cmp_lt_u32 s31, 6
  s_cselect_b32 s58, 10, s63
  s_cselect_b32 s61, s61, s30
  s_cselect_b32 s60, s60, 0
  s_cselect_b32 s59, 12, 3
  s_lshl_b32 s59, s59, 10
  s_lshl_b32 s61, s61, 7
  s_mul_i32 s34, s59, 640
  s_sub_u32 s34, s34, s61
  s_mov_b32 s35, 0x20000
  v_mad_u32_u24 v2, v4, s59, v5
  s_lshl_b32 s64, s59, 5
  s_mul_i32 s64, s64, s3
  s_lshl_b32 s65, s59, 4
  s_lshl_b32 s66, s59, 2
  s_add_u32 s67, s65, s66
  s_lshl_b32 s68, s59, 7
  s_lshl_b32 s70, s3, 12
  s_movk_i32 s62, 0x400
  s_mov_b32 m0, s70
  s_lshl_b32 s71, s58, 12
  s_waitcnt lgkmcnt(0)
  s_cmp_eq_u32 s31, 6
  s_cselect_b32 s32, s16, s18
  s_cselect_b32 s33, s17, s19
  s_cmp_lt_u32 s31, 6
  s_cselect_b32 s32, s10, s32
  s_cselect_b32 s33, s11, s33
  s_add_u32 s32, s32, s61
  s_addc_u32 s33, s33, 0
  s_cmp_eq_u32 s58, 0
  s_cbranch_scc1 L_hb0
L_hi:
  buffer_load_dwordx4 v2, s[32:35], s64 offen nt lds
  s_add_u32 m0, m0, s62
  s_add_u32 s63, s64, s65
  buffer_load_dwordx4 v2, s[32:35], s63 offen nt lds
  s_add_u32 m0, m0, s62
  s_add_u32 s63, s64, s66
  buffer_load_dwordx4 v2, s[32:35], s63 offen nt lds
  s_add_u32 m0, m0, s62
  s_add_u32 s63, s64, s67
  buffer_load_dwordx4 v2, s[32:35], s63 offen nt lds
  s_add_u32 s64, s64, s68
  s_add_u32 m0, m0, 13312
  s_cmp_lt_u32 m0, s71
  s_cbranch_scc1 L_hi
L_hb0:
  s_load_dword s49, s[28:29], 0
  s_barrier
  s_branch L_h2
L_stream:
  s_sub_u32 s64, s3, 4
  s_lshl_b32 s65, s64, 10
  v_lshl_add_u32 v1, v0, 4, s65
  v_add_u32 v2, 0x8000, v1
  s_lshl_b32 s66, s30, 3
  s_add_u32 s66, s66, s31
  s_mul_i32 s66, s66, 196608
  s_sub_u32 s34, 201326592, s66
  s_mov_b32 s35, 0x20000
  s_lshr_b32 s70, s2, 6
  s_and_b32 s71, s2, 7
  s_mov_b32 s67, 0x53741630
  s_cmp_eq_u32 s70, 1
  s_cselect_b32 s67, 0x41660527, s67
  s_cmp_eq_u32 s70, 2
  s_cselect_b32 s67, 0x60637516, s67
  s_cmp_eq_u32 s70, 3
  s_cselect_b32 s67, 0x13416305, s67
  s_lshl_b32 s65, s31, 2
  s_lshr_b32 s67, s67, s65
  s_and_b32 s67, s67, 7
  s_mov_b32 s72, 0x41869418
  s_mov_b32 s73, 0x61825861
  s_lshr_b32 s65, s2, 3
  s_lshl_b32 s65, s65, 1
  s_lshr_b64 s[72:73], s[72:73], s65
  s_and_b32 s72, s72, 3
  s_lshl_b32 s71, s71, 1
  s_lshr_b32 s71, 0x492a, s71
  s_and_b32 s71, s71, 3
  s_add_u32 s72, s72, s71
  s_cmp_ge_u32 s72, 3
  s_cselect_b32 s65, 3, 0
  s_sub_u32 s72, s72, s65
  s_lshl_b32 s40, s67, 12
  s_movk_i32 s90, 0x1000
  s_mov_b32 s70, 0x18000
  s_sub_u32 s71, 0, s70
  s_lshr_b32 s65, 0x40000, s72
  s_and_b32 s65, s65, 0x30000
  s_add_u32 s40, s40, s65
  s_cmp_eq_u32 s72, 0
  s_cselect_b32 s91, s70, s71
  s_cmp_eq_u32 s72, 2
  s_cselect_b32 s92, s70, s71
  s_cmp_eq_u32 s72, 1
  s_cselect_b32 s93, s70, s71
  s_lshl_b32 s72, s72, 3
  s_add_u32 s67, s67, s72
  s_add_u32 s41, s40, s90
  s_bitcmp1_b32 s41, 15
  s_cselect_b32 s65, s91, 0
  s_add_u32 s41, s41, s65
  s_add_u32 s42, s41, s90
  s_bitcmp1_b32 s42, 15
  s_cselect_b32 s65, s91, 0
  s_add_u32 s42, s42, s65
  s_waitcnt lgkmcnt(0)
  s_add_u32 s32, s6, s66
  s_addc_u32 s33, s7, 0
  buffer_load_dwordx4 v[84:87], v1, s[32:35], s40 offen nt
  buffer_load_dwordx4 v[88:91], v2, s[32:35], s40 offen nt
  buffer_load_dwordx4 v[92:95], v1, s[32:35], s41 offen nt
  buffer_load_dwordx4 v[96:99], v2, s[32:35], s41 offen nt
  s_barrier
  buffer_load_dwordx4 v[100:103], v1, s[32:35], s42 offen nt
  s_load_dword s82, s[28:29], 0
  s_setprio 2
  s_add_u32 s43, s42, s90
  s_bitcmp1_b32 s43, 15
  s_cselect_b32 s65, s91, 0
  s_add_u32 s43, s43, s65
  s_add_u32 s44, s43, s90
  s_bitcmp1_b32 s44, 15
  s_cselect_b32 s65, s91, 0
  s_add_u32 s44, s44, s65
  s_mov_b32 s84, s28
  s_mov_b32 s85, s29
  s_mov_b32 s86, 872448
  s_mov_b32 s87, 0x20000
  s_and_b32 s83, s2, 7
  s_lshl_b32 s83, s83, 5
  s_lshr_b32 s65, s2, 3
  s_add_u32 s83, s83, s65
  s_lshl_b32 s83, s83, 2
  s_add_u32 s83, s83, s64
  s_lshl_b32 s83, s83, 2
  s_add_u32 s83, s83, 36864
  s_mov_b32 s88, 0x85ebca6b
  s_cmp_eq_u32 s64, 1
  s_cselect_b32 s88, 0xc2b2ae35, s88
  s_cmp_eq_u32 s64, 2
  s_cselect_b32 s88, 0x27d4eb2f, s88
  s_cmp_eq_u32 s64, 3
  s_cselect_b32 s88, 0x165667b1, s88
  s_getreg_b32 s89, hwreg(HW_REG_XCC_ID, 0, 4)
  s_lshl_b32 s89, s89, 28
  v_lshlrev_b32 v251, 24, v0
  s_lshl_b32 s65, s64, 3
  s_add_u32 s65, s65, 126784
  v_mov_b32 v250, s65
  v_mov_b32 v22, 0
  v_mov_b32 v23, 0
  s_waitcnt vmcnt(4)
  buffer_load_dwordx4 v[104:107], v2, s[32:35], s42 offen nt
  s_waitcnt vmcnt(4)
  buffer_load_dwordx4 v[108:111], v1, s[32:35], s43 offen nt
  s_waitcnt lgkmcnt(0)
  s_add_u32 s82, s82, 1
  s_mul_i32 s82, s82, s88
  s_xor_b32 s82, s82, s89
  s_and_b32 s82, s82, 0xffffff00
  s_add_u32 s82, s82, 2
  v_mov_b32 v252, s82
  v_add_u32 v252, 1, v252
  buffer_store_dword v252, v251, s[84:87], s83 offen
  s_add_u32 s45, s44, s90
  s_bitcmp1_b32 s45, 15
  s_cselect_b32 s65, s91, 0
  s_add_u32 s45, s45, s65
  s_add_u32 s46, s45, s90
  s_bitcmp1_b32 s46, 15
  s_cselect_b32 s65, s91, 0
  s_add_u32 s46, s46, s65
  s_waitcnt lgkmcnt(0)
  v_cmp_lt_u32 s[80:81], v252, v23
  v_cmp_lt_u32 vcc, v252, v22
  ds_read_b64 v[22:23], v250
  s_cmp_lg_u64 s[80:81], 0
  s_waitcnt vmcnt(7)
  s_cbranch_vccnz L_w9
  s_waitcnt vmcnt(5)
  s_cbranch_scc0 L_w9
  s_waitcnt vmcnt(4)
L_w9:
  buffer_load_dwordx4 v[112:115], v2, s[32:35], s43 offen nt
  s_waitcnt vmcnt(7)
  s_cbranch_vccnz L_w10
  s_waitcnt vmcnt(5)
  s_cbranch_scc0 L_w10
  s_waitcnt vmcnt(4)
L_w10:
  buffer_load_dwordx4 v[116:119], v1, s[32:35], s44 offen nt
  v_add_u32 v252, 1, v252
  buffer_store_dword v252, v251, s[84:87], s83 offen
  s_add_u32 s47, s46, s90
  s_bitcmp1_b32 s47, 15
  s_cselect_b32 s65, s91, 0
  s_add_u32 s47, s47, s65
  s_add_u32 s48, s47, s90
  s_bitcmp1_b32 s48, 15
  s_cselect_b32 s65, s91, 0
  s_add_u32 s48, s48, s65
  s_waitcnt lgkmcnt(0)
  v_cmp_lt_u32 s[80:81], v252, v23
  v_cmp_lt_u32 vcc, v252, v22
  ds_read_b64 v[22:23], v250
  s_cmp_lg_u64 s[80:81], 0
  s_waitcnt vmcnt(8)
  s_cbranch_vccnz L_w11
  s_waitcnt vmcnt(6)
  s_cbranch_scc0 L_w11
  s_waitcnt vmcnt(5)
L_w11:
  buffer_load_dwordx4 v[120:123], v2, s[32:35], s44 offen nt
  s_waitcnt vmcnt(8)
  s_cbranch_vccnz L_w12
  s_waitcnt vmcnt(6)
  s_cbranch_scc0 L_w12
  s_waitcnt vmcnt(5)
L_w12:
  buffer_load_dwordx4 v[124:127], v1, s[32:35], s45 offen nt
  v_add_u32 v252, 1, v252
  buffer_store_dword v252, v251, s[84:87], s83 offen
  s_add_u32 s49, s48, s90
  s_bitcmp1_b32 s49, 15
  s_cselect_b32 s65, s92, 0
  s_add_u32 s49, s49, s65
  s_add_u32 s50, s49, s90
  s_bitcmp1_b32 s50, 15
  s_cselect_b32 s65, s92, 0
  s_add_u32 s50, s50, s65
  s_waitcnt lgkmcnt(0)
  v_cmp_lt_u32 s[80:81], v252, v23
  v_cmp_lt_u32 vcc, v252, v22
  ds_read_b64 v[22:23], v250
  s_cmp_lg_u64 s[80:81], 0
  s_waitcnt vmcnt(9)
  s_cbranch_vccnz L_w13
  s_waitcnt vmcnt(7)
  s_cbranch_scc0 L_w13
  s_waitcnt vmcnt(5)
L_w13:
  buffer_load_dwordx4 v[128:131], v2, s[32:35], s45 offen nt
  s_waitcnt vmcnt(9)
  s_cbranch_vccnz L_w14
  s_waitcnt vmcnt(6)
  s_cbranch_scc0 L_w14
  s_waitcnt vmcnt(5)
L_w14:
  buffer_load_dwordx4 v[132:135], v1, s[32:35], s46 offen nt
  v_add_u32 v252, 1, v252
  buffer_store_dword v252, v251, s[84:87], s83 offen
  s_add_u32 s51, s50, s90
  s_bitcmp1_b32 s51, 15
  s_cselect_b32 s65, s92, 0
  s_add_u32 s51, s51, s65
  s_add_u32 s52, s51, s90
  s_bitcmp1_b32 s52, 15
  s_cselect_b32 s65, s92, 0
  s_add_u32 s52, s52, s65
  v_bfe_u32 v4, v0, 3, 2
  v_lshrrev_b32 v5, 5, v0
  v_lshl_add_u32 v4, v5, 3, v4
  v_lshrrev_b32 v5, 3, v0
  v_and_b32 v5, 6, v5
  v_xor_b32 v5, v5, v0
  v_and_b32 v5, 7, v5
  v_lshlrev_b32 v5, 4, v5
  s_movk_i32 s65, 1280
  v_mad_u32_u24 v3, v4, s65, v5
  s_waitcnt lgkmcnt(0)
  v_cmp_lt_u32 s[80:81], v252, v23
  v_cmp_lt_u32 vcc, v252, v22
  ds_read_b64 v[22:23], v250
  s_cmp_lg_u64 s[80:81], 0
  s_waitcnt vmcnt(10)
  s_cbranch_vccnz L_w15
  s_waitcnt vmcnt(7)
  s_cbranch_scc0 L_w15
  s_waitcnt vmcnt(5)
L_w15:
  buffer_load_dwordx4 v[136:139], v2, s[32:35], s46 offen nt
  s_waitcnt vmcnt(9)
  s_cbranch_vccnz L_w16
  s_waitcnt vmcnt(6)
  s_cbranch_scc0 L_w16
  s_waitcnt vmcnt(5)
L_w16:
  buffer_load_dwordx4 v[140:143], v1, s[32:35], s47 offen nt
  v_add_u32 v252, 1, v252
  buffer_store_dword v252, v251, s[84:87], s83 offen
  s_add_u32 s53, s52, s90
  s_bitcmp1_b32 s53, 15
  s_cselect_b32 s65, s92, 0
  s_add_u32 s53, s53, s65
  s_add_u32 s54, s53, s90
  s_bitcmp1_b32 s54, 15
  s_cselect_b32 s65, s92, 0
  s_add_u32 s54, s54, s65
  v_lshrrev_b32 v17, 3, v0
  s_lshl_b32 s65, s64, 5
  s_add_u32 s65, s65, 81920
  v_lshl_add_u32 v5, v17, 2, s65
  v_bfe_u32 v6, v0, 2, 1
  v_lshl_add_u32 v4, v6, 10, v5
  s_add_u32 s70, s64, s67
  s_lshl_b32 s70, s70, 1
  v_and_b32 v18, 7, v0
  s_add_u32 s68, s8, s66
  s_addc_u32 s69, s9, 0
  s_mov_b32 s78, 0
  s_mov_b32 s79, s34
  s_waitcnt lgkmcnt(0)
  v_cmp_lt_u32 s[80:81], v252, v23
  v_cmp_lt_u32 vcc, v252, v22
  ds_read_b64 v[22:23], v250
  s_cmp_lg_u64 s[80:81], 0
  s_waitcnt vmcnt(10)
  s_cbranch_vccnz L_w17
  s_waitcnt vmcnt(7)
  s_cbranch_scc0 L_w17
  s_waitcnt vmcnt(5)
L_w17:
  buffer_load_dwordx4 v[144:147], v2, s[32:35], s47 offen nt
  s_waitcnt vmcnt(9)
  s_cbranch_vccnz L_w18
  s_waitcnt vmcnt(6)
  s_cbranch_scc0 L_w18
  s_waitcnt vmcnt(5)
L_w18:
  buffer_load_dwordx4 v[148:151], v1, s[32:35], s48 offen nt
  v_add_u32 v252, 1, v252
  buffer_store_dword v252, v251, s[84:87], s83 offen
  s_add_u32 s55, s54, s90
  s_bitcmp1_b32 s55, 15
  s_cselect_b32 s65, s92, 0
  s_add_u32 s55, s55, s65
  s_add_u32 s56, s55, s90
  s_bitcmp1_b32 s56, 15
  s_cselect_b32 s65, s92, 0
  s_add_u32 s56, s56, s65
  s_add_u32 s65, s70, 0
  v_add_u32 v19, s65, v17
  v_mul_u32_u24 v20, 0xab, v19
  v_lshrrev_b32 v20, 9, v20
  v_mul_u32_u24 v20, 3, v20
  v_sub_u32 v19, v19, v20
  v_lshlrev_b32 v19, 7, v19
  v_lshl_add_u32 v19, v18, 4, v19
  v_add_u32 v7, 122880, v19
  s_mul_i32 s71, s65, 0xab
  s_lshr_b32 s71, s71, 9
  s_mul_i32 s71, s71, 3
  s_sub_u32 s65, s65, s71
  s_lshl_b32 s65, s65, 8
  s_mul_i32 s71, s64, 768
  s_add_u32 s65, s65, s71
  s_add_u32 s65, s65, 106496
  v_lshl_add_u32 v19, v18, 3, v17
  v_lshl_add_u32 v10, v19, 2, s65
  s_waitcnt lgkmcnt(0)
  v_cmp_lt_u32 s[80:81], v252, v23
  v_cmp_lt_u32 vcc, v252, v22
  ds_read_b64 v[22:23], v250
  s_cmp_lg_u64 s[80:81], 0
  s_waitcnt vmcnt(10)
  s_cbranch_vccnz L_w19
  s_waitcnt vmcnt(7)
  s_cbranch_scc0 L_w19
  s_waitcnt vmcnt(5)
L_w19:
  buffer_load_dwordx4 v[152:155], v2, s[32:35], s48 offen nt
  s_waitcnt vmcnt(9)
  s_cbranch_vccnz L_w20
  s_waitcnt vmcnt(6)
  s_cbranch_scc0 L_w20
  s_waitcnt vmcnt(5)
L_w20:
  buffer_load_dwordx4 v[156:159], v1, s[32:35], s49 offen nt
  v_add_u32 v252, 1, v252
  buffer_store_dword v252, v251, s[84:87], s83 offen
  s_add_u32 s57, s56, s90
  s_bitcmp1_b32 s57, 15
  s_cselect_b32 s65, s93, 0
  s_add_u32 s57, s57, s65
  s_add_u32 s58, s57, s90
  s_bitcmp1_b32 s58, 15
  s_cselect_b32 s65, s93, 0
  s_add_u32 s58, s58, s65
  s_add_u32 s65, s70, 1
  v_add_u32 v19, s65, v17
  v_mul_u32_u24 v20, 0xab, v19
  v_lshrrev_b32 v20, 9, v20
  v_mul_u32_u24 v20, 3, v20
  v_sub_u32 v19, v19, v20
  v_lshlrev_b32 v19, 7, v19
  v_lshl_add_u32 v19, v18, 4, v19
  v_add_u32 v8, 122880, v19
  s_mul_i32 s71, s65, 0xab
  s_lshr_b32 s71, s71, 9
  s_mul_i32 s71, s71, 3
  s_sub_u32 s65, s65, s71
  s_lshl_b32 s65, s65, 8
  s_mul_i32 s71, s64, 768
  s_add_u32 s65, s65, s71
  s_add_u32 s65, s65, 106496
  v_lshl_add_u32 v19, v18, 3, v17
  v_lshl_add_u32 v11, v19, 2, s65
  s_waitcnt lgkmcnt(0)
  v_cmp_lt_u32 s[80:81], v252, v23
  v_cmp_lt_u32 vcc, v252, v22
  ds_read_b64 v[22:23], v250
  s_cmp_lg_u64 s[80:81], 0
  s_waitcnt vmcnt(10)
  s_cbranch_vccnz L_w21
  s_waitcnt vmcnt(7)
  s_cbranch_scc0 L_w21
  s_waitcnt vmcnt(5)
L_w21:
  buffer_load_dwordx4 v[160:163], v2, s[32:35], s49 offen nt
  s_waitcnt vmcnt(9)
  s_cbranch_vccnz L_w22
  s_waitcnt vmcnt(6)
  s_cbranch_scc0 L_w22
  s_waitcnt vmcnt(5)
L_w22:
  buffer_load_dwordx4 v[164:167], v1, s[32:35], s50 offen nt
  v_add_u32 v252, 1, v252
  buffer_store_dword v252, v251, s[84:87], s83 offen
  s_add_u32 s59, s58, s90
  s_bitcmp1_b32 s59, 15
  s_cselect_b32 s65, s93, 0
  s_add_u32 s59, s59, s65
  s_add_u32 s60, s59, s90
  s_bitcmp1_b32 s60, 15
  s_cselect_b32 s65, s93, 0
  s_add_u32 s60, s60, s65
  s_add_u32 s65, s70, 2
  v_add_u32 v19, s65, v17
  v_mul_u32_u24 v20, 0xab, v19
  v_lshrrev_b32 v20, 9, v20
  v_mul_u32_u24 v20, 3, v20
  v_sub_u32 v19, v19, v20
  v_lshlrev_b32 v19, 7, v19
  v_lshl_add_u32 v19, v18, 4, v19
  v_add_u32 v9, 122880, v19
  s_mul_i32 s71, s65, 0xab
  s_lshr_b32 s71, s71, 9
  s_mul_i32 s71, s71, 3
  s_sub_u32 s65, s65, s71
  s_lshl_b32 s65, s65, 8
  s_mul_i32 s71, s64, 768
  s_add_u32 s65, s65, s71
  s_add_u32 s65, s65, 106496
  v_lshl_add_u32 v19, v18, 3, v17
  v_lshl_add_u32 v12, v19, 2, s65
  s_waitcnt lgkmcnt(0)
  v_cmp_lt_u32 s[80:81], v252, v23
  v_cmp_lt_u32 vcc, v252, v22
  ds_read_b64 v[22:23], v250
  s_cmp_lg_u64 s[80:81], 0
  s_waitcnt vmcnt(10)
  s_cbranch_vccnz L_w23
  s_waitcnt vmcnt(7)
  s_cbranch_scc0 L_w23
  s_waitcnt vmcnt(5)
L_w23:
  buffer_load_dwordx4 v[168:171], v2, s[32:35], s50 offen nt
  s_waitcnt vmcnt(9)
  s_cbranch_vccnz L_w24
  s_waitcnt vmcnt(6)
  s_cbranch_scc0 L_w24
  s_waitcnt vmcnt(5)
L_w24:
  buffer_load_dwordx4 v[172:175], v1, s[32:35], s51 offen nt
  v_add_u32 v252, 1, v252
  buffer_store_dword v252, v251, s[84:87], s83 offen
  s_add_u32 s61, s60, s90
  s_bitcmp1_b32 s61, 15
  s_cselect_b32 s65, s93, 0
  s_add_u32 s61, s61, s65
  s_add_u32 s62, s61, s90
  s_bitcmp1_b32 s62, 15
  s_cselect_b32 s65, s93, 0
  s_add_u32 s62, s62, s65
  s_mul_i32 s73, s30, 192
  s_lshl_b32 s74, s64, 6
  s_add_u32 s73, s73, s74
  s_lshl_b32 s74, s30, 6
  s_cmp_lt_u32 s30, 24
  s_cselect_b32 s74, s74, 0
  s_cselect_b32 s75, 81920, 0
  s_cmp_lt_u32 s64, 3
  s_cselect_b32 s73, s73, s74
  s_cselect_b32 s38, 81920, s75
  s_cselect_b32 s36, s12, s20
  s_cselect_b32 s37, s13, s21
  s_mul_i32 s73, s73, 1280
  s_add_u32 s36, s36, s73
  s_addc_u32 s37, s37, 0
  s_mov_b32 s39, 0x20000
  s_waitcnt lgkmcnt(0)
  v_cmp_lt_u32 s[80:81], v252, v23
  v_cmp_lt_u32 vcc, v252, v22
  ds_read_b64 v[22:23], v250
  s_cmp_lg_u64 s[80:81], 0
  s_waitcnt vmcnt(10)
  s_cbranch_vccnz L_w25
  s_waitcnt vmcnt(7)
  s_cbranch_scc0 L_w25
  s_waitcnt vmcnt(5)
L_w25:
  buffer_load_dwordx4 v[176:179], v2, s[32:35], s51 offen nt
  s_waitcnt vmcnt(9)
  s_cbranch_vccnz L_w26
  s_waitcnt vmcnt(6)
  s_cbranch_scc0 L_w26
  s_waitcnt vmcnt(5)
L_w26:
  buffer_load_dwordx4 v[180:183], v1, s[32:35], s52 offen nt
  v_add_u32 v252, 1, v252
  buffer_store_dword v252, v251, s[84:87], s83 offen
  s_add_u32 s63, s62, s90
  s_bitcmp1_b32 s63, 15
  s_cselect_b32 s65, s93, 0
  s_add_u32 s63, s63, s65
  s_lshl_b32 s72, s31, 7
  s_and_b32 s73, s31, 3
  s_mul_i32 s73, s73, 20480
  s_lshr_b32 s74, s31, 2
  s_lshl_b32 s74, s74, 7
  s_add_u32 s73, s73, s74
  s_lshl_b32 s76, s64, 13
  s_lshr_b32 s77, s64, 1
  s_lshl_b32 s77, s77, 12
  s_and_b32 s74, s64, 1
  s_lshl_b32 s74, s74, 10
  s_add_u32 s77, s77, s74
  s_waitcnt lgkmcnt(0)
  v_cmp_lt_u32 s[80:81], v252, v23
  v_cmp_lt_u32 vcc, v252, v22
  ds_read_b64 v[22:23], v250
  s_cmp_lg_u64 s[80:81], 0
  s_waitcnt vmcnt(10)
  s_cbranch_vccnz L_w27
  s_waitcnt vmcnt(7)
  s_cbranch_scc0 L_w27
  s_waitcnt vmcnt(5)
L_w27:
  buffer_load_dwordx4 v[184:187], v2, s[32:35], s52 offen nt
  s_waitcnt vmcnt(9)
  s_cbranch_vccnz L_w28
  s_waitcnt vmcnt(6)
  s_cbranch_scc0 L_w28
  s_waitcnt vmcnt(5)
L_w28:
  buffer_load_dwordx4 v[188:191], v1, s[32:35], s53 offen nt
  v_add_u32 v252, 1, v252
  buffer_store_dword v252, v251, s[84:87], s83 offen
  s_waitcnt lgkmcnt(0)
  v_cmp_lt_u32 s[80:81], v252, v23
  v_cmp_lt_u32 vcc, v252, v22
  ds_read_b64 v[22:23], v250
  s_cmp_lg_u64 s[80:81], 0
  s_waitcnt vmcnt(10)
  s_cbranch_vccnz L_w29
  s_waitcnt vmcnt(7)
  s_cbranch_scc0 L_w29
  s_waitcnt vmcnt(5)
L_w29:
  buffer_load_dwordx4 v[192:195], v2, s[32:35], s53 offen nt
  s_waitcnt vmcnt(9)
  s_cbranch_vccnz L_w30
  s_waitcnt vmcnt(6)
  s_cbranch_scc0 L_w30
  s_waitcnt vmcnt(5)
L_w30:
  buffer_load_dwordx4 v[196:199], v1, s[32:35], s54 offen nt
  v_add_u32 v252, 1, v252
  buffer_store_dword v252, v251, s[84:87], s83 offen
  s_waitcnt lgkmcnt(0)
  v_cmp_lt_u32 s[80:81], v252, v23
  v_cmp_lt_u32 vcc, v252, v22
  ds_read_b64 v[22:23], v250
  s_cmp_lg_u64 s[80:81], 0
  s_waitcnt vmcnt(10)
  s_cbranch_vccnz L_w31
  s_waitcnt vmcnt(7)
  s_cbranch_scc0 L_w31
  s_waitcnt vmcnt(5)
L_w31:
  buffer_load_dwordx4 v[200:203], v2, s[32:35], s54 offen nt
  s_waitcnt vmcnt(9)
  s_cbranch_vccnz L_w32
  s_waitcnt vmcnt(6)
  s_cbranch_scc0 L_w32
  s_waitcnt vmcnt(5)
L_w32:
  buffer_load_dwordx4 v[204:207], v1, s[32:35], s55 offen nt
  v_add_u32 v252, 1, v252
  buffer_store_dword v252, v251, s[84:87], s83 offen
  s_waitcnt lgkmcnt(0)
  v_cmp_lt_u32 s[80:81], v252, v23
  v_cmp_lt_u32 vcc, v252, v22
  ds_read_b64 v[22:23], v250
  s_cmp_lg_u64 s[80:81], 0
  s_waitcnt vmcnt(10)
  s_cbranch_vccnz L_w33
  s_waitcnt vmcnt(7)
  s_cbranch_scc0 L_w33
  s_waitcnt vmcnt(5)
L_w33:
  buffer_load_dwordx4 v[208:211], v2, s[32:35], s55 offen nt
  s_waitcnt vmcnt(9)
  s_cbranch_vccnz L_w34
  s_waitcnt vmcnt(6)
  s_cbranch_scc0 L_w34
  s_waitcnt vmcnt(5)
L_w34:
  buffer_load_dwordx4 v[212:215], v1, s[32:35], s56 offen nt
  v_add_u32 v252, 1, v252
  buffer_store_dword v252, v251, s[84:87], s83 offen
  s_waitcnt lgkmcnt(0)
  v_cmp_lt_u32 s[80:81], v252, v23
  v_cmp_lt_u32 vcc, v252, v22
  ds_read_b64 v[22:23], v250
  s_cmp_lg_u64 s[80:81], 0
  s_waitcnt vmcnt(10)
  s_cbranch_vccnz L_w35
  s_waitcnt vmcnt(7)
  s_cbranch_scc0 L_w35
  s_waitcnt vmcnt(5)
L_w35:
  buffer_load_dwordx4 v[216:219], v2, s[32:35], s56 offen nt
  s_waitcnt vmcnt(9)
  s_cbranch_vccnz L_w36
  s_waitcnt vmcnt(6)
  s_cbranch_scc0 L_w36
  s_waitcnt vmcnt(5)
L_w36:
  buffer_load_dwordx4 v[220:223], v1, s[32:35], s57 offen nt
  v_add_u32 v252, 1, v252
  buffer_store_dword v252, v251, s[84:87], s83 offen
  s_waitcnt lgkmcnt(0)
  v_cmp_lt_u32 s[80:81], v252, v23
  v_cmp_lt_u32 vcc, v252, v22
  ds_read_b64 v[22:23], v250
  s_cmp_lg_u64 s[80:81], 0
  s_waitcnt vmcnt(10)
  s_cbranch_vccnz L_w37
  s_waitcnt vmcnt(7)
  s_cbranch_scc0 L_w37
  s_waitcnt vmcnt(5)
L_w37:
  buffer_load_dwordx4 v[224:227], v2, s[32:35], s57 offen nt
  s_barrier
  ds_read_b128 v[24:27], v7
  ds_read_b128 v[28:31], v8
  ds_read_b128 v[32:35], v9
  v_add_u32 v7, 384, v7
  v_add_u32 v8, 384, v8
  v_add_u32 v9, 384, v9
  s_waitcnt vmcnt(9)
  s_cbranch_vccnz L_w38
  s_waitcnt vmcnt(6)
  s_cbranch_scc0 L_w38
  s_waitcnt vmcnt(5)
L_w38:
  buffer_load_dwordx4 v[36:39], v1, s[32:35], s58 offen nt
  v_add_u32 v252, 1, v252
  buffer_store_dword v252, v251, s[84:87], s83 offen
  s_waitcnt lgkmcnt(0)
  v_cmp_lt_u32 s[80:81], v252, v23
  v_cmp_lt_u32 vcc, v252, v22
  ds_read_b64 v[22:23], v250
  s_cmp_lg_u64 s[80:81], 0
  s_waitcnt vmcnt(10)
  s_cbranch_vccnz L_w39
  s_waitcnt vmcnt(7)
  s_cbranch_scc0 L_w39
  s_waitcnt vmcnt(5)
L_w39:
  buffer_load_dwordx4 v[40:43], v2, s[32:35], s58 offen nt
  s_waitcnt vmcnt(9)
  s_cbranch_vccnz L_w40
  s_waitcnt vmcnt(6)
  s_cbranch_scc0 L_w40
  s_waitcnt vmcnt(5)
L_w40:
  buffer_load_dwordx4 v[44:47], v1, s[32:35], s59 offen nt
  v_add_u32 v252, 1, v252
  buffer_store_dword v252, v251, s[84:87], s83 offen
  s_waitcnt lgkmcnt(0)
  v_cmp_lt_u32 s[80:81], v252, v23
  v_cmp_lt_u32 vcc, v252, v22
  ds_read_b64 v[22:23], v250
  s_cmp_lg_u64 s[80:81], 0
  s_waitcnt lgkmcnt(0)
  v_mov_b32 v13, 0
  v_dot2c_f32_bf16 v13, v84, v24
  v_dot2c_f32_bf16 v13, v85, v25
  v_dot2c_f32_bf16 v13, v86, v26
  v_dot2c_f32_bf16 v13, v87, v27
  v_mov_b32 v14, 0
  v_dot2c_f32_bf16 v14, v88, v28
  v_dot2c_f32_bf16 v14, v89, v29
  v_add_f32_dpp v15, v13, v13 row_half_mirror row_mask:0xf bank_mask:0x5
  v_dot2c_f32_bf16 v14, v90, v30
  v_dot2c_f32_bf16 v14, v91, v31
  v_mov_b32 v13, 0
  s_nop 1
  v_add_f32_dpp v15, v14, v14 row_half_mirror row_mask:0xf bank_mask:0xa
  v_dot2c_f32_bf16 v13, v92, v32
  v_dot2c_f32_bf16 v13, v93, v33
  v_add_f32_dpp v15, v15, v15 quad_perm:[1,0,3,2] row_mask:0xf bank_mask:0xf
  v_dot2c_f32_bf16 v13, v94, v34
  v_dot2c_f32_bf16 v13, v95, v35
  v_add_f32_dpp v15, v15, v15 quad_perm:[2,3,0,1] row_mask:0xf bank_mask:0xf
  v_bfe_u32 v6, s40, 5, 16
  v_add_u32 v6, v6, v4
  ds_write_b32 v6, v15
  s_waitcnt vmcnt(10)
  s_cbranch_vccnz L_w41
  s_waitcnt vmcnt(7)
  s_cbranch_scc0 L_w41
  s_waitcnt vmcnt(5)
L_w41:
  buffer_load_dwordx4 v[48:51], v2, s[32:35], s59 offen nt
  v_mov_b32 v14, 0
  v_dot2c_f32_bf16 v14, v96, v24
  v_dot2c_f32_bf16 v14, v97, v25
  v_add_f32_dpp v15, v13, v13 row_half_mirror row_mask:0xf bank_mask:0x5
  v_dot2c_f32_bf16 v14, v98, v26
  v_dot2c_f32_bf16 v14, v99, v27
  v_mov_b32 v13, 0
  s_nop 1
  v_add_f32_dpp v15, v14, v14 row_half_mirror row_mask:0xf bank_mask:0xa
  v_dot2c_f32_bf16 v13, v100, v28
  v_dot2c_f32_bf16 v13, v101, v29
  v_add_f32_dpp v15, v15, v15 quad_perm:[1,0,3,2] row_mask:0xf bank_mask:0xf
  v_dot2c_f32_bf16 v13, v102, v30
  v_dot2c_f32_bf16 v13, v103, v31
  v_add_f32_dpp v15, v15, v15 quad_perm:[2,3,0,1] row_mask:0xf bank_mask:0xf
  v_bfe_u32 v6, s41, 5, 16
  v_add_u32 v6, v6, v4
  ds_write_b32 v6, v15
  v_mov_b32 v14, 0
  v_dot2c_f32_bf16 v14, v104, v32
  v_dot2c_f32_bf16 v14, v105, v33
  v_add_f32_dpp v15, v13, v13 row_half_mirror row_mask:0xf bank_mask:0x5
  v_dot2c_f32_bf16 v14, v106, v34
  v_dot2c_f32_bf16 v14, v107, v35
  v_mov_b32 v13, 0
  s_nop 1
  v_add_f32_dpp v15, v14, v14 row_half_mirror row_mask:0xf bank_mask:0xa
  v_dot2c_f32_bf16 v13, v108, v24
  v_dot2c_f32_bf16 v13, v109, v25
  v_add_f32_dpp v15, v15, v15 quad_perm:[1,0,3,2] row_mask:0xf bank_mask:0xf
  v_dot2c_f32_bf16 v13, v110, v26
  v_dot2c_f32_bf16 v13, v111, v27
  v_add_f32_dpp v15, v15, v15 quad_perm:[2,3,0,1] row_mask:0xf bank_mask:0xf
  v_bfe_u32 v6, s42, 5, 16
  v_add_u32 v6, v6, v4
  ds_write_b32 v6, v15
  s_waitcnt vmcnt(9)
  s_cbranch_vccnz L_w42
  s_waitcnt vmcnt(6)
  s_cbranch_scc0 L_w42
  s_waitcnt vmcnt(5)
L_w42:
  buffer_load_dwordx4 v[52:55], v1, s[32:35], s60 offen nt
  v_add_u32 v252, 1, v252
  buffer_store_dword v252, v251, s[84:87], s83 offen
  s_waitcnt lgkmcnt(0)
  v_cmp_lt_u32 s[80:81], v252, v23
  v_cmp_lt_u32 vcc, v252, v22
  ds_read_b64 v[22:23], v250
  s_cmp_lg_u64 s[80:81], 0
  v_mov_b32 v14, 0
  v_dot2c_f32_bf16 v14, v112, v28
  v_dot2c_f32_bf16 v14, v113, v29
  v_add_f32_dpp v15, v13, v13 row_half_mirror row_mask:0xf bank_mask:0x5
  v_dot2c_f32_bf16 v14, v114, v30
  v_dot2c_f32_bf16 v14, v115, v31
  v_mov_b32 v13, 0
  s_nop 1
  v_add_f32_dpp v15, v14, v14 row_half_mirror row_mask:0xf bank_mask:0xa
  v_dot2c_f32_bf16 v13, v116, v32
  v_dot2c_f32_bf16 v13, v117, v33
  v_add_f32_dpp v15, v15, v15 quad_perm:[1,0,3,2] row_mask:0xf bank_mask:0xf
  v_dot2c_f32_bf16 v13, v118, v34
  v_dot2c_f32_bf16 v13, v119, v35
  v_add_f32_dpp v15, v15, v15 quad_perm:[2,3,0,1] row_mask:0xf bank_mask:0xf
  v_bfe_u32 v6, s43, 5, 16
  v_add_u32 v6, v6, v4
  ds_write_b32 v6, v15
  v_mov_b32 v14, 0
  v_dot2c_f32_bf16 v14, v120, v24
  v_dot2c_f32_bf16 v14, v121, v25
  v_add_f32_dpp v15, v13, v13 row_half_mirror row_mask:0xf bank_mask:0x5
  v_dot2c_f32_bf16 v14, v122, v26
  v_dot2c_f32_bf16 v14, v123, v27
  v_mov_b32 v13, 0
  s_nop 1
  v_add_f32_dpp v15, v14, v14 row_half_mirror row_mask:0xf bank_mask:0xa
  v_dot2c_f32_bf16 v13, v124, v28
  v_dot2c_f32_bf16 v13, v125, v29
  v_add_f32_dpp v15, v15, v15 quad_perm:[1,0,3,2] row_mask:0xf bank_mask:0xf
  v_dot2c_f32_bf16 v13, v126, v30
  v_dot2c_f32_bf16 v13, v127, v31
  v_add_f32_dpp v15, v15, v15 quad_perm:[2,3,0,1] row_mask:0xf bank_mask:0xf
  v_bfe_u32 v6, s44, 5, 16
  v_add_u32 v6, v6, v4
  ds_write_b32 v6, v15
  s_waitcnt vmcnt(10)
  s_cbranch_vccnz L_w43
  s_waitcnt vmcnt(7)
  s_cbranch_scc0 L_w43
  s_waitcnt vmcnt(5)
L_w43:
  buffer_load_dwordx4 v[56:59], v2, s[32:35], s60 offen nt
  v_mov_b32 v14, 0
  v_dot2c_f32_bf16 v14, v128, v32
  v_dot2c_f32_bf16 v14, v129, v33
  v_add_f32_dpp v15, v13, v13 row_half_mirror row_mask:0xf bank_mask:0x5
  v_dot2c_f32_bf16 v14, v130, v34
  v_dot2c_f32_bf16 v14, v131, v35
  v_mov_b32 v13, 0
  s_nop 1
  v_add_f32_dpp v15, v14, v14 row_half_mirror row_mask:0xf bank_mask:0xa
  v_dot2c_f32_bf16 v13, v132, v24
  v_dot2c_f32_bf16 v13, v133, v25
  v_add_f32_dpp v15, v15, v15 quad_perm:[1,0,3,2] row_mask:0xf bank_mask:0xf
  v_dot2c_f32_bf16 v13, v134, v26
  v_dot2c_f32_bf16 v13, v135, v27
  v_add_f32_dpp v15, v15, v15 quad_perm:[2,3,0,1] row_mask:0xf bank_mask:0xf
  v_bfe_u32 v6, s45, 5, 16
  v_add_u32 v6, v6, v4
  ds_write_b32 v6, v15
  v_mov_b32 v14, 0
  v_dot2c_f32_bf16 v14, v136, v28
  v_dot2c_f32_bf16 v14, v137, v29
  v_add_f32_dpp v15, v13, v13 row_half_mirror row_mask:0xf bank_mask:0x5
  v_dot2c_f32_bf16 v14, v138, v30
  v_dot2c_f32_bf16 v14, v139, v31
  v_mov_b32 v13, 0
  s_nop 1
  v_add_f32_dpp v15, v14, v14 row_half_mirror row_mask:0xf bank_mask:0xa
  v_dot2c_f32_bf16 v13, v140, v32
  v_dot2c_f32_bf16 v13, v141, v33
  v_add_f32_dpp v15, v15, v15 quad_perm:[1,0,3,2] row_mask:0xf bank_mask:0xf
  v_dot2c_f32_bf16 v13, v142, v34
  v_dot2c_f32_bf16 v13, v143, v35
  v_add_f32_dpp v15, v15, v15 quad_perm:[2,3,0,1] row_mask:0xf bank_mask:0xf
  v_bfe_u32 v6, s46, 5, 16
  v_add_u32 v6, v6, v4
  ds_write_b32 v6, v15
  s_waitcnt vmcnt(9)
  s_cbranch_vccnz L_w44
  s_waitcnt vmcnt(6)
  s_cbranch_scc0 L_w44
  s_waitcnt vmcnt(5)
L_w44:
  buffer_load_dwordx4 v[60:63], v1, s[32:35], s61 offen nt
  v_add_u32 v252, 1, v252
  buffer_store_dword v252, v251, s[84:87], s83 offen
  s_waitcnt lgkmcnt(0)
  v_cmp_lt_u32 s[80:81], v252, v23
  v_cmp_lt_u32 vcc, v252, v22
  ds_read_b64 v[22:23], v250
  s_cmp_lg_u64 s[80:81], 0
  v_mov_b32 v14, 0
  v_dot2c_f32_bf16 v14, v144, v24
  v_dot2c_f32_bf16 v14, v145, v25
  v_add_f32_dpp v15, v13, v13 row_half_mirror row_mask:0xf bank_mask:0x5
  v_dot2c_f32_bf16 v14, v146, v26
  v_dot2c_f32_bf16 v14, v147, v27
  v_mov_b32 v13, 0
  s_nop 1
  v_add_f32_dpp v15, v14, v14 row_half_mirror row_mask:0xf bank_mask:0xa
  v_dot2c_f32_bf16 v13, v148, v28
  v_dot2c_f32_bf16 v13, v149, v29
  v_add_f32_dpp v15, v15, v15 quad_perm:[1,0,3,2] row_mask:0xf bank_mask:0xf
  v_dot2c_f32_bf16 v13, v150, v30
  v_dot2c_f32_bf16 v13, v151, v31
  v_add_f32_dpp v15, v15, v15 quad_perm:[2,3,0,1] row_mask:0xf bank_mask:0xf
  v_bfe_u32 v6, s47, 5, 16
  v_add_u32 v6, v6, v4
  ds_write_b32 v6, v15
  v_mov_b32 v14, 0
  v_dot2c_f32_bf16 v14, v152, v32
  v_dot2c_f32_bf16 v14, v153, v33
  v_add_f32_dpp v15, v13, v13 row_half_mirror row_mask:0xf bank_mask:0x5
  v_dot2c_f32_bf16 v14, v154, v34
  v_dot2c_f32_bf16 v14, v155, v35
  s_waitcnt vmcnt(10)
  s_cbranch_vccnz L_w45
  s_waitcnt vmcnt(7)
  s_cbranch_scc0 L_w45
  s_waitcnt vmcnt(5)
L_w45:
  buffer_load_dwordx4 v[64:67], v2, s[32:35], s61 offen nt
  v_mov_b32 v13, 0
  v_add_f32_dpp v15, v14, v14 row_half_mirror row_mask:0xf bank_mask:0xa
  v_dot2c_f32_bf16 v13, v156, v24
  v_dot2c_f32_bf16 v13, v157, v25
  v_add_f32_dpp v15, v15, v15 quad_perm:[1,0,3,2] row_mask:0xf bank_mask:0xf
  v_dot2c_f32_bf16 v13, v158, v26
  v_dot2c_f32_bf16 v13, v159, v27
  v_add_f32_dpp v15, v15, v15 quad_perm:[2,3,0,1] row_mask:0xf bank_mask:0xf
  v_bfe_u32 v6, s48, 5, 16
  v_add_u32 v6, v6, v4
  ds_write_b32 v6, v15
  v_mov_b32 v14, 0
  v_dot2c_f32_bf16 v14, v160, v28
  v_dot2c_f32_bf16 v14, v161, v29
  v_add_f32_dpp v15, v13, v13 row_half_mirror row_mask:0xf bank_mask:0x5
  v_dot2c_f32_bf16 v14, v162, v30
  v_dot2c_f32_bf16 v14, v163, v31
  v_mov_b32 v13, 0
  s_nop 1
  v_add_f32_dpp v15, v14, v14 row_half_mirror row_mask:0xf bank_mask:0xa
  v_dot2c_f32_bf16 v13, v164, v32
  v_dot2c_f32_bf16 v13, v165, v33
  v_add_f32_dpp v15, v15, v15 quad_perm:[1,0,3,2] row_mask:0xf bank_mask:0xf
  v_dot2c_f32_bf16 v13, v166, v34
  v_dot2c_f32_bf16 v13, v167, v35
  v_add_f32_dpp v15, v15, v15 quad_perm:[2,3,0,1] row_mask:0xf bank_mask:0xf
  v_bfe_u32 v6, s49, 5, 16
  v_add_u32 v6, v6, v4
  ds_write_b32 v6, v15
  v_mov_b32 v14, 0
  v_dot2c_f32_bf16 v14, v168, v24
  v_dot2c_f32_bf16 v14, v169, v25
  v_add_f32_dpp v15, v13, v13 row_half_mirror row_mask:0xf bank_mask:0x5
  v_dot2c_f32_bf16 v14, v170, v26
  v_dot2c_f32_bf16 v14, v171, v27
  s_waitcnt vmcnt(9)
  s_cbranch_vccnz L_w46
  s_waitcnt vmcnt(6)
  s_cbranch_scc0 L_w46
  s_waitcnt vmcnt(5)
L_w46:
  buffer_load_dwordx4 v[68:71], v1, s[32:35], s62 offen nt
  v_add_u32 v252, 1, v252
  buffer_store_dword v252, v251, s[84:87], s83 offen
  s_waitcnt lgkmcnt(0)
  v_cmp_lt_u32 s[80:81], v252, v23
  v_cmp_lt_u32 vcc, v252, v22
  ds_read_b64 v[22:23], v250
  s_cmp_lg_u64 s[80:81], 0
  v_mov_b32 v13, 0
  v_add_f32_dpp v15, v14, v14 row_half_mirror row_mask:0xf bank_mask:0xa
  v_dot2c_f32_bf16 v13, v172, v28
  v_dot2c_f32_bf16 v13, v173, v29
  v_add_f32_dpp v15, v15, v15 quad_perm:[1,0,3,2] row_mask:0xf bank_mask:0xf
  v_dot2c_f32_bf16 v13, v174, v30
  v_dot2c_f32_bf16 v13, v175, v31
  v_add_f32_dpp v15, v15, v15 quad_perm:[2,3,0,1] row_mask:0xf bank_mask:0xf
  v_bfe_u32 v6, s50, 5, 16
  v_add_u32 v6, v6, v4
  ds_write_b32 v6, v15
  v_mov_b32 v14, 0
  v_dot2c_f32_bf16 v14, v176, v32
  v_dot2c_f32_bf16 v14, v177, v33
  v_add_f32_dpp v15, v13, v13 row_half_mirror row_mask:0xf bank_mask:0x5
  v_dot2c_f32_bf16 v14, v178, v34
  v_dot2c_f32_bf16 v14, v179, v35
  v_mov_b32 v13, 0
  s_nop 1
  v_add_f32_dpp v15, v14, v14 row_half_mirror row_mask:0xf bank_mask:0xa
  v_dot2c_f32_bf16 v13, v180, v24
  v_dot2c_f32_bf16 v13, v181, v25
  v_add_f32_dpp v15, v15, v15 quad_perm:[1,0,3,2] row_mask:0xf bank_mask:0xf
  v_dot2c_f32_bf16 v13, v182, v26
  v_dot2c_f32_bf16 v13, v183, v27
  v_add_f32_dpp v15, v15, v15 quad_perm:[2,3,0,1] row_mask:0xf bank_mask:0xf
  v_bfe_u32 v6, s51, 5, 16
  v_add_u32 v6, v6, v4
  ds_write_b32 v6, v15
  v_mov_b32 v14, 0
  v_dot2c_f32_bf16 v14, v184, v28
  v_dot2c_f32_bf16 v14, v185, v29
  v_add_f32_dpp v15, v13, v13 row_half_mirror row_mask:0xf bank_mask:0x5
  v_dot2c_f32_bf16 v14, v186, v30
  v_dot2c_f32_bf16 v14, v187, v31
  s_waitcnt vmcnt(10)
  s_cbranch_vccnz L_w47
  s_waitcnt vmcnt(7)
  s_cbranch_scc0 L_w47
  s_waitcnt vmcnt(5)
L_w47:
  buffer_load_dwordx4 v[72:75], v2, s[32:35], s62 offen nt
  v_mov_b32 v13, 0
  v_add_f32_dpp v15, v14, v14 row_half_mirror row_mask:0xf bank_mask:0xa
  v_dot2c_f32_bf16 v13, v188, v32
  v_dot2c_f32_bf16 v13, v189, v33
  v_add_f32_dpp v15, v15, v15 quad_perm:[1,0,3,2] row_mask:0xf bank_mask:0xf
  v_dot2c_f32_bf16 v13, v190, v34
  v_dot2c_f32_bf16 v13, v191, v35
  v_add_f32_dpp v15, v15, v15 quad_perm:[2,3,0,1] row_mask:0xf bank_mask:0xf
  v_bfe_u32 v6, s52, 5, 16
  v_add_u32 v6, v6, v4
  ds_write_b32 v6, v15
  v_mov_b32 v14, 0
  v_dot2c_f32_bf16 v14, v192, v24
  v_dot2c_f32_bf16 v14, v193, v25
  v_add_f32_dpp v15, v13, v13 row_half_mirror row_mask:0xf bank_mask:0x5
  v_dot2c_f32_bf16 v14, v194, v26
  v_dot2c_f32_bf16 v14, v195, v27
  v_mov_b32 v13, 0
  s_nop 1
  v_add_f32_dpp v15, v14, v14 row_half_mirror row_mask:0xf bank_mask:0xa
  v_dot2c_f32_bf16 v13, v196, v28
  v_dot2c_f32_bf16 v13, v197, v29
  v_add_f32_dpp v15, v15, v15 quad_perm:[1,0,3,2] row_mask:0xf bank_mask:0xf
  v_dot2c_f32_bf16 v13, v198, v30
  v_dot2c_f32_bf16 v13, v199, v31
  v_add_f32_dpp v15, v15, v15 quad_perm:[2,3,0,1] row_mask:0xf bank_mask:0xf
  v_bfe_u32 v6, s53, 5, 16
  v_add_u32 v6, v6, v4
  ds_write_b32 v6, v15
  v_mov_b32 v14, 0
  v_dot2c_f32_bf16 v14, v200, v32
  v_dot2c_f32_bf16 v14, v201, v33
  v_add_f32_dpp v15, v13, v13 row_half_mirror row_mask:0xf bank_mask:0x5
  v_dot2c_f32_bf16 v14, v202, v34
  v_dot2c_f32_bf16 v14, v203, v35
  s_waitcnt vmcnt(9)
  s_cbranch_vccnz L_w48
  s_waitcnt vmcnt(6)
  s_cbranch_scc0 L_w48
  s_waitcnt vmcnt(5)
L_w48:
  buffer_load_dwordx4 v[76:79], v1, s[32:35], s63 offen nt
  v_add_u32 v252, 1, v252
  buffer_store_dword v252, v251, s[84:87], s83 offen
  s_waitcnt lgkmcnt(0)
  v_cmp_lt_u32 s[80:81], v252, v23
  v_cmp_lt_u32 vcc, v252, v22
  ds_read_b64 v[22:23], v250
  s_cmp_lg_u64 s[80:81], 0
  v_mov_b32 v13, 0
  v_add_f32_dpp v15, v14, v14 row_half_mirror row_mask:0xf bank_mask:0xa
  v_dot2c_f32_bf16 v13, v204, v24
  v_dot2c_f32_bf16 v13, v205, v25
  v_add_f32_dpp v15, v15, v15 quad_perm:[1,0,3,2] row_mask:0xf bank_mask:0xf
  v_dot2c_f32_bf16 v13, v206, v26
  v_dot2c_f32_bf16 v13, v207, v27
  v_add_f32_dpp v15, v15, v15 quad_perm:[2,3,0,1] row_mask:0xf bank_mask:0xf
  v_bfe_u32 v6, s54, 5, 16
  v_add_u32 v6, v6, v4
  ds_write_b32 v6, v15
  v_mov_b32 v14, 0
  v_dot2c_f32_bf16 v14, v208, v28
  v_dot2c_f32_bf16 v14, v209, v29
  v_add_f32_dpp v15, v13, v13 row_half_mirror row_mask:0xf bank_mask:0x5
  v_dot2c_f32_bf16 v14, v210, v30
  v_dot2c_f32_bf16 v14, v211, v31
  v_mov_b32 v13, 0
  s_nop 1
  v_add_f32_dpp v15, v14, v14 row_half_mirror row_mask:0xf bank_mask:0xa
  v_dot2c_f32_bf16 v13, v212, v32
  v_dot2c_f32_bf16 v13, v213, v33
  v_add_f32_dpp v15, v15, v15 quad_perm:[1,0,3,2] row_mask:0xf bank_mask:0xf
  v_dot2c_f32_bf16 v13, v214, v34
  v_dot2c_f32_bf16 v13, v215, v35
  v_add_f32_dpp v15, v15, v15 quad_perm:[2,3,0,1] row_mask:0xf bank_mask:0xf
  v_bfe_u32 v6, s55, 5, 16
  v_add_u32 v6, v6, v4
  ds_write_b32 v6, v15
  v_mov_b32 v14, 0
  v_dot2c_f32_bf16 v14, v216, v24
  v_dot2c_f32_bf16 v14, v217, v25
  v_add_f32_dpp v15, v13, v13 row_half_mirror row_mask:0xf bank_mask:0x5
  v_dot2c_f32_bf16 v14, v218, v26
  v_dot2c_f32_bf16 v14, v219, v27
  s_waitcnt vmcnt(10)
  s_cbranch_vccnz L_w49
  s_waitcnt vmcnt(7)
  s_cbranch_scc0 L_w49
  s_waitcnt vmcnt(5)
L_w49:
  buffer_load_dwordx4 v[80:83], v2, s[32:35], s63 offen nt
  v_mov_b32 v13, 0
  v_add_f32_dpp v15, v14, v14 row_half_mirror row_mask:0xf bank_mask:0xa
  v_dot2c_f32_bf16 v13, v220, v28
  v_dot2c_f32_bf16 v13, v221, v29
  v_add_f32_dpp v15, v15, v15 quad_perm:[1,0,3,2] row_mask:0xf bank_mask:0xf
  v_dot2c_f32_bf16 v13, v222, v30
  v_dot2c_f32_bf16 v13, v223, v31
  v_add_f32_dpp v15, v15, v15 quad_perm:[2,3,0,1] row_mask:0xf bank_mask:0xf
  v_bfe_u32 v6, s56, 5, 16
  v_add_u32 v6, v6, v4
  ds_write_b32 v6, v15
  v_mov_b32 v14, 0
  v_dot2c_f32_bf16 v14, v224, v32
  v_dot2c_f32_bf16 v14, v225, v33
  v_add_f32_dpp v15, v13, v13 row_half_mirror row_mask:0xf bank_mask:0x5
  v_dot2c_f32_bf16 v14, v226, v34
  v_dot2c_f32_bf16 v14, v227, v35
  v_mov_b32 v13, 0
  s_nop 1
  v_add_f32_dpp v15, v14, v14 row_half_mirror row_mask:0xf bank_mask:0xa
  v_dot2c_f32_bf16 v13, v36, v24
  v_dot2c_f32_bf16 v13, v37, v25
  v_add_f32_dpp v15, v15, v15 quad_perm:[1,0,3,2] row_mask:0xf bank_mask:0xf
  v_dot2c_f32_bf16 v13, v38, v26
  v_dot2c_f32_bf16 v13, v39, v27
  v_add_f32_dpp v15, v15, v15 quad_perm:[2,3,0,1] row_mask:0xf bank_mask:0xf
  v_bfe_u32 v6, s57, 5, 16
  v_add_u32 v6, v6, v4
  ds_write_b32 v6, v15
  s_waitcnt vmcnt(9)
  s_cbranch_vccnz L_w50
  s_waitcnt vmcnt(6)
  s_cbranch_scc0 L_w50
  s_waitcnt vmcnt(5)
L_w50:
  s_add_u32 s32, s32, 50331648
  s_addc_u32 s33, s33, 0
  s_sub_u32 s34, s34, 50331648
  s_cmp_lg_u64 s[80:81], 0
  buffer_load_dwordx4 v[36:39], v1, s[32:35], s40 offen nt
  v_add_u32 v252, 1, v252
  buffer_store_dword v252, v251, s[84:87], s83 offen
  s_waitcnt lgkmcnt(0)
  v_cmp_lt_u32 s[80:81], v252, v23
  v_cmp_lt_u32 vcc, v252, v22
  ds_read_b64 v[22:23], v250
  s_cmp_lg_u64 s[80:81], 0
  v_mov_b32 v14, 0
  v_dot2c_f32_bf16 v14, v40, v28
  v_dot2c_f32_bf16 v14, v41, v29
  v_add_f32_dpp v15, v13, v13 row_half_mirror row_mask:0xf bank_mask:0x5
  v_dot2c_f32_bf16 v14, v42, v30
  v_dot2c_f32_bf16 v14, v43, v31
  s_waitcnt vmcnt(10)
  s_cbranch_vccnz L_w51
  s_waitcnt vmcnt(7)
  s_cbranch_scc0 L_w51
  s_waitcnt vmcnt(5)
L_w51:
  buffer_load_dwordx4 v[40:43], v2, s[32:35], s40 offen nt
  v_mov_b32 v13, 0
  v_add_f32_dpp v15, v14, v14 row_half_mirror row_mask:0xf bank_mask:0xa
  v_dot2c_f32_bf16 v13, v44, v32
  v_dot2c_f32_bf16 v13, v45, v33
  v_add_f32_dpp v15, v15, v15 quad_perm:[1,0,3,2] row_mask:0xf bank_mask:0xf
  v_dot2c_f32_bf16 v13, v46, v34
  v_dot2c_f32_bf16 v13, v47, v35
  v_add_f32_dpp v15, v15, v15 quad_perm:[2,3,0,1] row_mask:0xf bank_mask:0xf
  v_bfe_u32 v6, s58, 5, 16
  v_add_u32 v6, v6, v4
  ds_write_b32 v6, v15
  s_waitcnt vmcnt(9)
  s_cbranch_vccnz L_w52
  s_waitcnt vmcnt(6)
  s_cbranch_scc0 L_w52
  s_waitcnt vmcnt(5)
L_w52:
  buffer_load_dwordx4 v[44:47], v1, s[32:35], s41 offen nt
  v_add_u32 v252, 1, v252
  buffer_store_dword v252, v251, s[84:87], s83 offen
  s_waitcnt lgkmcnt(0)
  v_cmp_lt_u32 s[80:81], v252, v23
  v_cmp_lt_u32 vcc, v252, v22
  ds_read_b64 v[22:23], v250
  s_cmp_lg_u64 s[80:81], 0
  v_mov_b32 v14, 0
  v_dot2c_f32_bf16 v14, v48, v24
  v_dot2c_f32_bf16 v14, v49, v25
  v_add_f32_dpp v15, v13, v13 row_half_mirror row_mask:0xf bank_mask:0x5
  v_dot2c_f32_bf16 v14, v50, v26
  v_dot2c_f32_bf16 v14, v51, v27
  s_waitcnt vmcnt(10)
  s_cbranch_vccnz L_w53
  s_waitcnt vmcnt(7)
  s_cbranch_scc0 L_w53
  s_waitcnt vmcnt(5)
L_w53:
  buffer_load_dwordx4 v[48:51], v2, s[32:35], s41 offen nt
  v_mov_b32 v13, 0
  v_add_f32_dpp v15, v14, v14 row_half_mirror row_mask:0xf bank_mask:0xa
  v_dot2c_f32_bf16 v13, v52, v28
  v_dot2c_f32_bf16 v13, v53, v29
  v_add_f32_dpp v15, v15, v15 quad_perm:[1,0,3,2] row_mask:0xf bank_mask:0xf
  v_dot2c_f32_bf16 v13, v54, v30
  v_dot2c_f32_bf16 v13, v55, v31
  v_add_f32_dpp v15, v15, v15 quad_perm:[2,3,0,1] row_mask:0xf bank_mask:0xf
  v_bfe_u32 v6, s59, 5, 16
  v_add_u32 v6, v6, v4
  ds_write_b32 v6, v15
  s_waitcnt vmcnt(9)
  s_cbranch_vccnz L_w54
  s_waitcnt vmcnt(6)
  s_cbranch_scc0 L_w54
  s_waitcnt vmcnt(5)
L_w54:
  buffer_load_dwordx4 v[52:55], v1, s[32:35], s42 offen nt
  v_add_u32 v252, 1, v252
  buffer_store_dword v252, v251, s[84:87], s83 offen
  s_waitcnt lgkmcnt(0)
  v_cmp_lt_u32 s[80:81], v252, v23
  v_cmp_lt_u32 vcc, v252, v22
  ds_read_b64 v[22:23], v250
  s_cmp_lg_u64 s[80:81], 0
  v_mov_b32 v14, 0
  v_dot2c_f32_bf16 v14, v56, v32
  v_dot2c_f32_bf16 v14, v57, v33
  v_add_f32_dpp v15, v13, v13 row_half_mirror row_mask:0xf bank_mask:0x5
  v_dot2c_f32_bf16 v14, v58, v34
  v_dot2c_f32_bf16 v14, v59, v35
  s_waitcnt vmcnt(10)
  s_cbranch_vccnz L_w55
  s_waitcnt vmcnt(7)
  s_cbranch_scc0 L_w55
  s_waitcnt vmcnt(5)
L_w55:
  buffer_load_dwordx4 v[56:59], v2, s[32:35], s42 offen nt
  v_mov_b32 v13, 0
  v_add_f32_dpp v15, v14, v14 row_half_mirror row_mask:0xf bank_mask:0xa
  v_dot2c_f32_bf16 v13, v60, v24
  v_dot2c_f32_bf16 v13, v61, v25
  v_add_f32_dpp v15, v15, v15 quad_perm:[1,0,3,2] row_mask:0xf bank_mask:0xf
  v_dot2c_f32_bf16 v13, v62, v26
  v_dot2c_f32_bf16 v13, v63, v27
  v_add_f32_dpp v15, v15, v15 quad_perm:[2,3,0,1] row_mask:0xf bank_mask:0xf
  v_bfe_u32 v6, s60, 5, 16
  v_add_u32 v6, v6, v4
  ds_write_b32 v6, v15
  s_waitcnt vmcnt(9)
  s_cbranch_vccnz L_w56
  s_waitcnt vmcnt(6)
  s_cbranch_scc0 L_w56
  s_waitcnt vmcnt(5)
L_w56:
  buffer_load_dwordx4 v[60:63], v1, s[32:35], s43 offen nt
  v_add_u32 v252, 1, v252
  buffer_store_dword v252, v251, s[84:87], s83 offen
  s_waitcnt lgkmcnt(0)
  v_cmp_lt_u32 s[80:81], v252, v23
  v_cmp_lt_u32 vcc, v252, v22
  ds_read_b64 v[22:23], v250
  s_cmp_lg_u64 s[80:81], 0
  v_mov_b32 v14, 0
  v_dot2c_f32_bf16 v14, v64, v28
  v_dot2c_f32_bf16 v14, v65, v29
  v_add_f32_dpp v15, v13, v13 row_half_mirror row_mask:0xf bank_mask:0x5
  v_dot2c_f32_bf16 v14, v66, v30
  v_dot2c_f32_bf16 v14, v67, v31
  s_waitcnt vmcnt(10)
  s_cbranch_vccnz L_w57
  s_waitcnt vmcnt(7)
  s_cbranch_scc0 L_w57
  s_waitcnt vmcnt(5)
L_w57:
  buffer_load_dwordx4 v[64:67], v2, s[32:35], s43 offen nt
  v_mov_b32 v13, 0
  v_add_f32_dpp v15, v14, v14 row_half_mirror row_mask:0xf bank_mask:0xa
  v_dot2c_f32_bf16 v13, v68, v32
  v_dot2c_f32_bf16 v13, v69, v33
  v_add_f32_dpp v15, v15, v15 quad_perm:[1,0,3,2] row_mask:0xf bank_mask:0xf
  v_dot2c_f32_bf16 v13, v70, v34
  v_dot2c_f32_bf16 v13, v71, v35
  v_add_f32_dpp v15, v15, v15 quad_perm:[2,3,0,1] row_mask:0xf bank_mask:0xf
  v_bfe_u32 v6, s61, 5, 16
  v_add_u32 v6, v6, v4
  ds_write_b32 v6, v15
  s_waitcnt vmcnt(9)
  s_cbranch_vccnz L_w58
  s_waitcnt vmcnt(6)
  s_cbranch_scc0 L_w58
  s_waitcnt vmcnt(5)
L_w58:
  buffer_load_dwordx4 v[68:71], v1, s[32:35], s44 offen nt
  v_add_u32 v252, 1, v252
  buffer_store_dword v252, v251, s[84:87], s83 offen
  s_waitcnt lgkmcnt(0)
  v_cmp_lt_u32 s[80:81], v252, v23
  v_cmp_lt_u32 vcc, v252, v22
  ds_read_b64 v[22:23], v250
  s_cmp_lg_u64 s[80:81], 0
  v_mov_b32 v14, 0
  v_dot2c_f32_bf16 v14, v72, v24
  v_dot2c_f32_bf16 v14, v73, v25
  v_add_f32_dpp v15, v13, v13 row_half_mirror row_mask:0xf bank_mask:0x5
  v_dot2c_f32_bf16 v14, v74, v26
  v_dot2c_f32_bf16 v14, v75, v27
  s_waitcnt vmcnt(10)
  s_cbranch_vccnz L_w59
  s_waitcnt vmcnt(7)
  s_cbranch_scc0 L_w59
  s_waitcnt vmcnt(5)
L_w59:
  buffer_load_dwordx4 v[72:75], v2, s[32:35], s44 offen nt
  v_mov_b32 v13, 0
  v_add_f32_dpp v15, v14, v14 row_half_mirror row_mask:0xf bank_mask:0xa
  v_dot2c_f32_bf16 v13, v76, v28
  v_dot2c_f32_bf16 v13, v77, v29
  v_add_f32_dpp v15, v15, v15 quad_perm:[1,0,3,2] row_mask:0xf bank_mask:0xf
  v_dot2c_f32_bf16 v13, v78, v30
  v_dot2c_f32_bf16 v13, v79, v31
  v_add_f32_dpp v15, v15, v15 quad_perm:[2,3,0,1] row_mask:0xf bank_mask:0xf
  v_bfe_u32 v6, s62, 5, 16
  v_add_u32 v6, v6, v4
  ds_write_b32 v6, v15
  s_waitcnt vmcnt(9)
  s_cbranch_vccnz L_w60
  s_waitcnt vmcnt(6)
  s_cbranch_scc0 L_w60
  s_waitcnt vmcnt(5)
L_w60:
  buffer_load_dwordx4 v[76:79], v1, s[32:35], s45 offen nt
  v_add_u32 v252, 1, v252
  buffer_store_dword v252, v251, s[84:87], s83 offen
  s_waitcnt lgkmcnt(0)
  v_cmp_lt_u32 s[80:81], v252, v23
  v_cmp_lt_u32 vcc, v252, v22
  ds_read_b64 v[22:23], v250
  s_cmp_lg_u64 s[80:81], 0
  v_mov_b32 v14, 0
  v_dot2c_f32_bf16 v14, v80, v32
  v_dot2c_f32_bf16 v14, v81, v33
  v_add_f32_dpp v15, v13, v13 row_half_mirror row_mask:0xf bank_mask:0x5
  v_dot2c_f32_bf16 v14, v82, v34
  v_dot2c_f32_bf16 v14, v83, v35
  ds_read_b128 v[24:27], v7
  ds_read_b128 v[28:31], v8
  ds_read_b128 v[32:35], v9
  v_add_u32 v7, 384, v7
  v_add_u32 v8, 384, v8
  v_add_u32 v9, 384, v9
  v_add_f32_dpp v15, v14, v14 row_half_mirror row_mask:0xf bank_mask:0xa
  s_nop 1
  v_add_f32_dpp v15, v15, v15 quad_perm:[1,0,3,2] row_mask:0xf bank_mask:0xf
  s_nop 1
  v_add_f32_dpp v15, v15, v15 quad_perm:[2,3,0,1] row_mask:0xf bank_mask:0xf
  v_bfe_u32 v6, s63, 5, 16
  v_add_u32 v6, v6, v4
  ds_write_b32 v6, v15
  v_add_u32 v4, 6144, v4
  s_add_u32 s78, s78, 1
  s_waitcnt lgkmcnt(0)
  s_barrier
L_kloop:
  s_cmp_lg_u64 s[80:81], 0
  s_waitcnt vmcnt(10)
  s_cbranch_vccnz L_w61
  s_waitcnt vmcnt(7)
  s_cbranch_scc0 L_w61
  s_waitcnt vmcnt(5)
L_w61:
  buffer_load_dwordx4 v[80:83], v2, s[32:35], s45 offen nt
  s_waitcnt lgkmcnt(0)
  v_cmp_lt_u32 s[80:81], v252, v23
  v_cmp_lt_u32 vcc, v252, v22
  ds_read_b64 v[22:23], v250
  s_cmp_lg_u64 s[80:81], 0
  v_mov_b32 v13, 0
  v_dot2c_f32_bf16 v13, v36, v24
  v_dot2c_f32_bf16 v13, v37, v25
  v_dot2c_f32_bf16 v13, v38, v26
  v_dot2c_f32_bf16 v13, v39, v27
  s_waitcnt vmcnt(9)
  s_cbranch_vccnz L_w62
  s_waitcnt vmcnt(6)
  s_cbranch_scc0 L_w62
  s_waitcnt vmcnt(5)
L_w62:
  buffer_load_dwordx4 v[36:39], v1, s[32:35], s46 offen nt
  v_add_u32 v252, 1, v252
  buffer_store_dword v252, v251, s[84:87], s83 offen
  v_mov_b32 v14, 0
  v_dot2c_f32_bf16 v14, v40, v28
  v_dot2c_f32_bf16 v14, v41, v29
  v_add_f32_dpp v15, v13, v13 row_half_mirror row_mask:0xf bank_mask:0x5
  v_dot2c_f32_bf16 v14, v42, v30
  v_dot2c_f32_bf16 v14, v43, v31
  s_waitcnt vmcnt(10)
  s_cbranch_vccnz L_w63
  s_waitcnt vmcnt(7)
  s_cbranch_scc0 L_w63
  s_waitcnt vmcnt(5)
L_w63:
  buffer_load_dwordx4 v[40:43], v2, s[32:35], s46 offen nt
  s_waitcnt lgkmcnt(0)
  v_cmp_lt_u32 s[80:81], v252, v23
  v_cmp_lt_u32 vcc, v252, v22
  ds_read_b64 v[22:23], v250
  s_cmp_lg_u64 s[80:81], 0
  v_mov_b32 v13, 0
  v_add_f32_dpp v15, v14, v14 row_half_mirror row_mask:0xf bank_mask:0xa
  v_dot2c_f32_bf16 v13, v44, v32
  v_dot2c_f32_bf16 v13, v45, v33
  v_add_f32_dpp v15, v15, v15 quad_perm:[1,0,3,2] row_mask:0xf bank_mask:0xf
  v_dot2c_f32_bf16 v13, v46, v34
  v_dot2c_f32_bf16 v13, v47, v35
  v_add_f32_dpp v15, v15, v15 quad_perm:[2,3,0,1] row_mask:0xf bank_mask:0xf
  v_bfe_u32 v6, s40, 5, 16
  v_add_u32 v6, v6, v4
  ds_write_b32 v6, v15
  s_waitcnt vmcnt(9)
  s_cbranch_vccnz L_w64
  s_waitcnt vmcnt(6)
  s_cbranch_scc0 L_w64
  s_waitcnt vmcnt(5)
L_w64:
  buffer_load_dwordx4 v[44:47], v1, s[32:35], s47 offen nt
  v_add_u32 v252, 1, v252
  buffer_store_dword v252, v251, s[84:87], s83 offen
  v_mov_b32 v14, 0
  v_dot2c_f32_bf16 v14, v48, v24
  v_dot2c_f32_bf16 v14, v49, v25
  v_add_f32_dpp v15, v13, v13 row_half_mirror row_mask:0xf bank_mask:0x5
  v_dot2c_f32_bf16 v14, v50, v26
  v_dot2c_f32_bf16 v14, v51, v27
  s_waitcnt vmcnt(10)
  s_cbranch_vccnz L_w65
  s_waitcnt vmcnt(7)
  s_cbranch_scc0 L_w65
  s_waitcnt vmcnt(5)
L_w65:
  buffer_load_dwordx4 v[48:51], v2, s[32:35], s47 offen nt
  s_waitcnt lgkmcnt(0)
  v_cmp_lt_u32 s[80:81], v252, v23
  v_cmp_lt_u32 vcc, v252, v22
  ds_read_b64 v[22:23], v250
  s_cmp_lg_u64 s[80:81], 0
  v_mov_b32 v13, 0
  v_add_f32_dpp v15, v14, v14 row_half_mirror row_mask:0xf bank_mask:0xa
  v_dot2c_f32_bf16 v13, v52, v28
  v_dot2c_f32_bf16 v13, v53, v29
  v_add_f32_dpp v15, v15, v15 quad_perm:[1,0,3,2] row_mask:0xf bank_mask:0xf
  v_dot2c_f32_bf16 v13, v54, v30
  v_dot2c_f32_bf16 v13, v55, v31
  v_add_f32_dpp v15, v15, v15 quad_perm:[2,3,0,1] row_mask:0xf bank_mask:0xf
  v_bfe_u32 v6, s41, 5, 16
  v_add_u32 v6, v6, v4
  ds_write_b32 v6, v15
  s_waitcnt vmcnt(9)
  s_cbranch_vccnz L_w66
  s_waitcnt vmcnt(6)
  s_cbranch_scc0 L_w66
  s_waitcnt vmcnt(5)
L_w66:
  buffer_load_dwordx4 v[52:55], v1, s[32:35], s48 offen nt
  v_add_u32 v252, 1, v252
  buffer_store_dword v252, v251, s[84:87], s83 offen
  v_mov_b32 v14, 0
  v_dot2c_f32_bf16 v14, v56, v32
  v_dot2c_f32_bf16 v14, v57, v33
  v_add_f32_dpp v15, v13, v13 row_half_mirror row_mask:0xf bank_mask:0x5
  v_dot2c_f32_bf16 v14, v58, v34
  v_dot2c_f32_bf16 v14, v59, v35
  s_waitcnt vmcnt(10)
  s_cbranch_vccnz L_w67
  s_waitcnt vmcnt(7)
  s_cbranch_scc0 L_w67
  s_waitcnt vmcnt(5)
L_w67:
  buffer_load_dwordx4 v[56:59], v2, s[32:35], s48 offen nt
  s_waitcnt lgkmcnt(0)
  v_cmp_lt_u32 s[80:81], v252, v23
  v_cmp_lt_u32 vcc, v252, v22
  ds_read_b64 v[22:23], v250
  s_cmp_lg_u64 s[80:81], 0
  v_mov_b32 v13, 0
  v_add_f32_dpp v15, v14, v14 row_half_mirror row_mask:0xf bank_mask:0xa
  v_dot2c_f32_bf16 v13, v60, v24
  v_dot2c_f32_bf16 v13, v61, v25
  v_add_f32_dpp v15, v15, v15 quad_perm:[1,0,3,2] row_mask:0xf bank_mask:0xf
  v_dot2c_f32_bf16 v13, v62, v26
  v_dot2c_f32_bf16 v13, v63, v27
  v_add_f32_dpp v15, v15, v15 quad_perm:[2,3,0,1] row_mask:0xf bank_mask:0xf
  v_bfe_u32 v6, s42, 5, 16
  v_add_u32 v6, v6, v4
  ds_write_b32 v6, v15
  s_waitcnt vmcnt(9)
  s_cbranch_vccnz L_w68
  s_waitcnt vmcnt(6)
  s_cbranch_scc0 L_w68
  s_waitcnt vmcnt(5)
L_w68:
  buffer_load_dwordx4 v[60:63], v1, s[32:35], s49 offen nt
  v_add_u32 v252, 1, v252
  buffer_store_dword v252, v251, s[84:87], s83 offen
  v_mov_b32 v14, 0
  v_dot2c_f32_bf16 v14, v64, v28
  v_dot2c_f32_bf16 v14, v65, v29
  v_add_f32_dpp v15, v13, v13 row_half_mirror row_mask:0xf bank_mask:0x5
  v_dot2c_f32_bf16 v14, v66, v30
  v_dot2c_f32_bf16 v14, v67, v31
  s_waitcnt vmcnt(10)
  s_cbranch_vccnz L_w69
  s_waitcnt vmcnt(7)
  s_cbranch_scc0 L_w69
  s_waitcnt vmcnt(5)
L_w69:
  buffer_load_dwordx4 v[64:67], v2, s[32:35], s49 offen nt
  s_waitcnt lgkmcnt(0)
  v_cmp_lt_u32 s[80:81], v252, v23
  v_cmp_lt_u32 vcc, v252, v22
  ds_read_b64 v[22:23], v250
  s_cmp_lg_u64 s[80:81], 0
  v_mov_b32 v13, 0
  v_add_f32_dpp v15, v14, v14 row_half_mirror row_mask:0xf bank_mask:0xa
  v_dot2c_f32_bf16 v13, v68, v32
  v_dot2c_f32_bf16 v13, v69, v33
  v_add_f32_dpp v15, v15, v15 quad_perm:[1,0,3,2] row_mask:0xf bank_mask:0xf
  v_dot2c_f32_bf16 v13, v70, v34
  v_dot2c_f32_bf16 v13, v71, v35
  v_add_f32_dpp v15, v15, v15 quad_perm:[2,3,0,1] row_mask:0xf bank_mask:0xf
  v_bfe_u32 v6, s43, 5, 16
  v_add_u32 v6, v6, v4
  ds_write_b32 v6, v15
  s_waitcnt vmcnt(9)
  s_cbranch_vccnz L_w70
  s_waitcnt vmcnt(6)
  s_cbranch_scc0 L_w70
  s_waitcnt vmcnt(5)
L_w70:
  buffer_load_dwordx4 v[68:71], v1, s[32:35], s50 offen nt
  v_add_u32 v252, 1, v252
  buffer_store_dword v252, v251, s[84:87], s83 offen
  v_mov_b32 v14, 0
  v_dot2c_f32_bf16 v14, v72, v24
  v_dot2c_f32_bf16 v14, v73, v25
  v_add_f32_dpp v15, v13, v13 row_half_mirror row_mask:0xf bank_mask:0x5
  v_dot2c_f32_bf16 v14, v74, v26
  v_dot2c_f32_bf16 v14, v75, v27
  s_waitcnt vmcnt(10)
  s_cbranch_vccnz L_w71
  s_waitcnt vmcnt(7)
  s_cbranch_scc0 L_w71
  s_waitcnt vmcnt(5)
L_w71:
  buffer_load_dwordx4 v[72:75], v2, s[32:35], s50 offen nt
  s_waitcnt lgkmcnt(0)
  v_cmp_lt_u32 s[80:81], v252, v23
  v_cmp_lt_u32 vcc, v252, v22
  ds_read_b64 v[22:23], v250
  s_cmp_lg_u64 s[80:81], 0
  v_mov_b32 v13, 0
  v_add_f32_dpp v15, v14, v14 row_half_mirror row_mask:0xf bank_mask:0xa
  v_dot2c_f32_bf16 v13, v76, v28
  v_dot2c_f32_bf16 v13, v77, v29
  v_add_f32_dpp v15, v15, v15 quad_perm:[1,0,3,2] row_mask:0xf bank_mask:0xf
  v_dot2c_f32_bf16 v13, v78, v30
  v_dot2c_f32_bf16 v13, v79, v31
  v_add_f32_dpp v15, v15, v15 quad_perm:[2,3,0,1] row_mask:0xf bank_mask:0xf
  v_bfe_u32 v6, s44, 5, 16
  v_add_u32 v6, v6, v4
  ds_write_b32 v6, v15
  s_waitcnt vmcnt(9)
  s_cbranch_vccnz L_w72
  s_waitcnt vmcnt(6)
  s_cbranch_scc0 L_w72
  s_waitcnt vmcnt(5)
L_w72:
  buffer_load_dwordx4 v[76:79], v1, s[32:35], s51 offen nt
  v_add_u32 v252, 1, v252
  buffer_store_dword v252, v251, s[84:87], s83 offen
  v_mov_b32 v14, 0
  v_dot2c_f32_bf16 v14, v80, v32
  v_dot2c_f32_bf16 v14, v81, v33
  v_add_f32_dpp v15, v13, v13 row_half_mirror row_mask:0xf bank_mask:0x5
  v_dot2c_f32_bf16 v14, v82, v34
  v_dot2c_f32_bf16 v14, v83, v35
  s_waitcnt vmcnt(10)
  s_cbranch_vccnz L_w73
  s_waitcnt vmcnt(7)
  s_cbranch_scc0 L_w73
  s_waitcnt vmcnt(5)
L_w73:
  buffer_load_dwordx4 v[80:83], v2, s[32:35], s51 offen nt
  s_waitcnt lgkmcnt(0)
  v_cmp_lt_u32 s[80:81], v252, v23
  v_cmp_lt_u32 vcc, v252, v22
  ds_read_b64 v[22:23], v250
  s_cmp_lg_u64 s[80:81], 0
  v_mov_b32 v13, 0
  v_add_f32_dpp v15, v14, v14 row_half_mirror row_mask:0xf bank_mask:0xa
  v_dot2c_f32_bf16 v13, v36, v24
  v_dot2c_f32_bf16 v13, v37, v25
  v_add_f32_dpp v15, v15, v15 quad_perm:[1,0,3,2] row_mask:0xf bank_mask:0xf
  v_dot2c_f32_bf16 v13, v38, v26
  v_dot2c_f32_bf16 v13, v39, v27
  v_add_f32_dpp v15, v15, v15 quad_perm:[2,3,0,1] row_mask:0xf bank_mask:0xf
  v_bfe_u32 v6, s45, 5, 16
  v_add_u32 v6, v6, v4
  ds_write_b32 v6, v15
  s_waitcnt vmcnt(9)
  s_cbranch_vccnz L_w74
  s_waitcnt vmcnt(6)
  s_cbranch_scc0 L_w74
  s_waitcnt vmcnt(5)
L_w74:
  buffer_load_dwordx4 v[36:39], v1, s[32:35], s52 offen nt
  v_add_u32 v252, 1, v252
  buffer_store_dword v252, v251, s[84:87], s83 offen
  v_mov_b32 v14, 0
  v_dot2c_f32_bf16 v14, v40, v28
  v_dot2c_f32_bf16 v14, v41, v29
  v_add_f32_dpp v15, v13, v13 row_half_mirror row_mask:0xf bank_mask:0x5
  v_dot2c_f32_bf16 v14, v42, v30
  v_dot2c_f32_bf16 v14, v43, v31
  s_waitcnt vmcnt(10)
  s_cbranch_vccnz L_w75
  s_waitcnt vmcnt(7)
  s_cbranch_scc0 L_w75
  s_waitcnt vmcnt(5)
L_w75:
  buffer_load_dwordx4 v[40:43], v2, s[32:35], s52 offen nt
  s_waitcnt lgkmcnt(0)
  v_cmp_lt_u32 s[80:81], v252, v23
  v_cmp_lt_u32 vcc, v252, v22
  ds_read_b64 v[22:23], v250
  s_cmp_lg_u64 s[80:81], 0
  v_mov_b32 v13, 0
  v_add_f32_dpp v15, v14, v14 row_half_mirror row_mask:0xf bank_mask:0xa
  v_dot2c_f32_bf16 v13, v44, v32
  v_dot2c_f32_bf16 v13, v45, v33
  v_add_f32_dpp v15, v15, v15 quad_perm:[1,0,3,2] row_mask:0xf bank_mask:0xf
  v_dot2c_f32_bf16 v13, v46, v34
  v_dot2c_f32_bf16 v13, v47, v35
  v_add_f32_dpp v15, v15, v15 quad_perm:[2,3,0,1] row_mask:0xf bank_mask:0xf
  v_bfe_u32 v6, s46, 5, 16
  v_add_u32 v6, v6, v4
  ds_write_b32 v6, v15
  s_waitcnt vmcnt(9)
  s_cbranch_vccnz L_w76
  s_waitcnt vmcnt(6)
  s_cbranch_scc0 L_w76
  s_waitcnt vmcnt(5)
L_w76:
  buffer_load_dwordx4 v[44:47], v1, s[32:35], s53 offen nt
  v_add_u32 v252, 1, v252
  buffer_store_dword v252, v251, s[84:87], s83 offen
  v_mov_b32 v14, 0
  v_dot2c_f32_bf16 v14, v48, v24
  v_dot2c_f32_bf16 v14, v49, v25
  v_add_f32_dpp v15, v13, v13 row_half_mirror row_mask:0xf bank_mask:0x5
  v_dot2c_f32_bf16 v14, v50, v26
  v_dot2c_f32_bf16 v14, v51, v27
  s_waitcnt vmcnt(10)
  s_cbranch_vccnz L_w77
  s_waitcnt vmcnt(7)
  s_cbranch_scc0 L_w77
  s_waitcnt vmcnt(5)
L_w77:
  buffer_load_dwordx4 v[48:51], v2, s[32:35], s53 offen nt
  s_waitcnt lgkmcnt(0)
  v_cmp_lt_u32 s[80:81], v252, v23
  v_cmp_lt_u32 vcc, v252, v22
  ds_read_b64 v[22:23], v250
  s_cmp_lg_u64 s[80:81], 0
  v_mov_b32 v13, 0
  v_add_f32_dpp v15, v14, v14 row_half_mirror row_mask:0xf bank_mask:0xa
  v_dot2c_f32_bf16 v13, v52, v28
  v_dot2c_f32_bf16 v13, v53, v29
  v_add_f32_dpp v15, v15, v15 quad_perm:[1,0,3,2] row_mask:0xf bank_mask:0xf
  v_dot2c_f32_bf16 v13, v54, v30
  v_dot2c_f32_bf16 v13, v55, v31
  v_add_f32_dpp v15, v15, v15 quad_perm:[2,3,0,1] row_mask:0xf bank_mask:0xf
  v_bfe_u32 v6, s47, 5, 16
  v_add_u32 v6, v6, v4
  ds_write_b32 v6, v15
  s_waitcnt vmcnt(9)
  s_cbranch_vccnz L_w78
  s_waitcnt vmcnt(6)
  s_cbranch_scc0 L_w78
  s_waitcnt vmcnt(5)
L_w78:
  buffer_load_dwordx4 v[52:55], v1, s[32:35], s54 offen nt
  v_add_u32 v252, 1, v252
  buffer_store_dword v252, v251, s[84:87], s83 offen
  v_mov_b32 v14, 0
  v_dot2c_f32_bf16 v14, v56, v32
  v_dot2c_f32_bf16 v14, v57, v33
  v_add_f32_dpp v15, v13, v13 row_half_mirror row_mask:0xf bank_mask:0x5
  v_dot2c_f32_bf16 v14, v58, v34
  v_dot2c_f32_bf16 v14, v59, v35
  s_waitcnt vmcnt(10)
  s_cbranch_vccnz L_w79
  s_waitcnt vmcnt(7)
  s_cbranch_scc0 L_w79
  s_waitcnt vmcnt(5)
L_w79:
  buffer_load_dwordx4 v[56:59], v2, s[32:35], s54 offen nt
  s_waitcnt lgkmcnt(0)
  v_cmp_lt_u32 s[80:81], v252, v23
  v_cmp_lt_u32 vcc, v252, v22
  ds_read_b64 v[22:23], v250
  s_cmp_lg_u64 s[80:81], 0
  v_mov_b32 v13, 0
  v_add_f32_dpp v15, v14, v14 row_half_mirror row_mask:0xf bank_mask:0xa
  v_dot2c_f32_bf16 v13, v60, v24
  v_dot2c_f32_bf16 v13, v61, v25
  v_add_f32_dpp v15, v15, v15 quad_perm:[1,0,3,2] row_mask:0xf bank_mask:0xf
  v_dot2c_f32_bf16 v13, v62, v26
  v_dot2c_f32_bf16 v13, v63, v27
  v_add_f32_dpp v15, v15, v15 quad_perm:[2,3,0,1] row_mask:0xf bank_mask:0xf
  v_bfe_u32 v6, s48, 5, 16
  v_add_u32 v6, v6, v4
  ds_write_b32 v6, v15
  s_waitcnt vmcnt(9)
  s_cbranch_vccnz L_w80
  s_waitcnt vmcnt(6)
  s_cbranch_scc0 L_w80
  s_waitcnt vmcnt(5)
L_w80:
  buffer_load_dwordx4 v[60:63], v1, s[32:35], s55 offen nt
  v_add_u32 v252, 1, v252
  buffer_store_dword v252, v251, s[84:87], s83 offen
  v_mov_b32 v14, 0
  v_dot2c_f32_bf16 v14, v64, v28
  v_dot2c_f32_bf16 v14, v65, v29
  v_add_f32_dpp v15, v13, v13 row_half_mirror row_mask:0xf bank_mask:0x5
  v_dot2c_f32_bf16 v14, v66, v30
  v_dot2c_f32_bf16 v14, v67, v31
  s_waitcnt vmcnt(10)
  s_cbranch_vccnz L_w81
  s_waitcnt vmcnt(7)
  s_cbranch_scc0 L_w81
  s_waitcnt vmcnt(5)
L_w81:
  buffer_load_dwordx4 v[64:67], v2, s[32:35], s55 offen nt
  s_waitcnt lgkmcnt(0)
  v_cmp_lt_u32 s[80:81], v252, v23
  v_cmp_lt_u32 vcc, v252, v22
  ds_read_b64 v[22:23], v250
  s_cmp_lg_u64 s[80:81], 0
  v_mov_b32 v13, 0
  v_add_f32_dpp v15, v14, v14 row_half_mirror row_mask:0xf bank_mask:0xa
  v_dot2c_f32_bf16 v13, v68, v32
  v_dot2c_f32_bf16 v13, v69, v33
  v_add_f32_dpp v15, v15, v15 quad_perm:[1,0,3,2] row_mask:0xf bank_mask:0xf
  v_dot2c_f32_bf16 v13, v70, v34
  v_dot2c_f32_bf16 v13, v71, v35
  v_add_f32_dpp v15, v15, v15 quad_perm:[2,3,0,1] row_mask:0xf bank_mask:0xf
  v_bfe_u32 v6, s49, 5, 16
  v_add_u32 v6, v6, v4
  ds_write_b32 v6, v15
  s_waitcnt vmcnt(9)
  s_cbranch_vccnz L_w82
  s_waitcnt vmcnt(6)
  s_cbranch_scc0 L_w82
  s_waitcnt vmcnt(5)
L_w82:
  buffer_load_dwordx4 v[68:71], v1, s[32:35], s56 offen nt
  v_add_u32 v252, 1, v252
  buffer_store_dword v252, v251, s[84:87], s83 offen
  v_mov_b32 v14, 0
  v_dot2c_f32_bf16 v14, v72, v24
  v_dot2c_f32_bf16 v14, v73, v25
  v_add_f32_dpp v15, v13, v13 row_half_mirror row_mask:0xf bank_mask:0x5
  v_dot2c_f32_bf16 v14, v74, v26
  v_dot2c_f32_bf16 v14, v75, v27
  s_waitcnt vmcnt(10)
  s_cbranch_vccnz L_w83
  s_waitcnt vmcnt(7)
  s_cbranch_scc0 L_w83
  s_waitcnt vmcnt(5)
L_w83:
  buffer_load_dwordx4 v[72:75], v2, s[32:35], s56 offen nt
  s_waitcnt lgkmcnt(0)
  v_cmp_lt_u32 s[80:81], v252, v23
  v_cmp_lt_u32 vcc, v252, v22
  ds_read_b64 v[22:23], v250
  s_cmp_lg_u64 s[80:81], 0
  v_mov_b32 v13, 0
  v_add_f32_dpp v15, v14, v14 row_half_mirror row_mask:0xf bank_mask:0xa
  v_dot2c_f32_bf16 v13, v76, v28
  v_dot2c_f32_bf16 v13, v77, v29
  v_add_f32_dpp v15, v15, v15 quad_perm:[1,0,3,2] row_mask:0xf bank_mask:0xf
  v_dot2c_f32_bf16 v13, v78, v30
  v_dot2c_f32_bf16 v13, v79, v31
  v_add_f32_dpp v15, v15, v15 quad_perm:[2,3,0,1] row_mask:0xf bank_mask:0xf
  v_bfe_u32 v6, s50, 5, 16
  v_add_u32 v6, v6, v4
  ds_write_b32 v6, v15
  s_waitcnt vmcnt(9)
  s_cbranch_vccnz L_w84
  s_waitcnt vmcnt(6)
  s_cbranch_scc0 L_w84
  s_waitcnt vmcnt(5)
L_w84:
  buffer_load_dwordx4 v[76:79], v1, s[32:35], s57 offen nt
  v_add_u32 v252, 1, v252
  buffer_store_dword v252, v251, s[84:87], s83 offen
  v_mov_b32 v14, 0
  v_dot2c_f32_bf16 v14, v80, v32
  v_dot2c_f32_bf16 v14, v81, v33
  v_add_f32_dpp v15, v13, v13 row_half_mirror row_mask:0xf bank_mask:0x5
  v_dot2c_f32_bf16 v14, v82, v34
  v_dot2c_f32_bf16 v14, v83, v35
  s_waitcnt vmcnt(10)
  s_cbranch_vccnz L_w85
  s_waitcnt vmcnt(7)
  s_cbranch_scc0 L_w85
  s_waitcnt vmcnt(5)
L_w85:
  buffer_load_dwordx4 v[80:83], v2, s[32:35], s57 offen nt
  s_waitcnt lgkmcnt(0)
  v_cmp_lt_u32 s[80:81], v252, v23
  v_cmp_lt_u32 vcc, v252, v22
  ds_read_b64 v[22:23], v250
  s_cmp_lg_u64 s[80:81], 0
  v_mov_b32 v13, 0
  v_add_f32_dpp v15, v14, v14 row_half_mirror row_mask:0xf bank_mask:0xa
  v_dot2c_f32_bf16 v13, v36, v24
  v_dot2c_f32_bf16 v13, v37, v25
  v_add_f32_dpp v15, v15, v15 quad_perm:[1,0,3,2] row_mask:0xf bank_mask:0xf
  v_dot2c_f32_bf16 v13, v38, v26
  v_dot2c_f32_bf16 v13, v39, v27
  v_add_f32_dpp v15, v15, v15 quad_perm:[2,3,0,1] row_mask:0xf bank_mask:0xf
  v_bfe_u32 v6, s51, 5, 16
  v_add_u32 v6, v6, v4
  ds_write_b32 v6, v15
  s_waitcnt vmcnt(9)
  s_cbranch_vccnz L_w86
  s_waitcnt vmcnt(6)
  s_cbranch_scc0 L_w86
  s_waitcnt vmcnt(5)
L_w86:
  buffer_load_dwordx4 v[36:39], v1, s[32:35], s58 offen nt
  v_add_u32 v252, 1, v252
  buffer_store_dword v252, v251, s[84:87], s83 offen
  v_mov_b32 v14, 0
  v_dot2c_f32_bf16 v14, v40, v28
  v_dot2c_f32_bf16 v14, v41, v29
  v_add_f32_dpp v15, v13, v13 row_half_mirror row_mask:0xf bank_mask:0x5
  v_dot2c_f32_bf16 v14, v42, v30
  v_dot2c_f32_bf16 v14, v43, v31
  s_waitcnt vmcnt(10)
  s_cbranch_vccnz L_w87
  s_waitcnt vmcnt(7)
  s_cbranch_scc0 L_w87
  s_waitcnt vmcnt(5)
L_w87:
  buffer_load_dwordx4 v[40:43], v2, s[32:35], s58 offen nt
  s_waitcnt lgkmcnt(0)
  v_cmp_lt_u32 s[80:81], v252, v23
  v_cmp_lt_u32 vcc, v252, v22
  ds_read_b64 v[22:23], v250
  s_cmp_lg_u64 s[80:81], 0
  v_mov_b32 v13, 0
  v_add_f32_dpp v15, v14, v14 row_half_mirror row_mask:0xf bank_mask:0xa
  v_dot2c_f32_bf16 v13, v44, v32
  v_dot2c_f32_bf16 v13, v45, v33
  v_add_f32_dpp v15, v15, v15 quad_perm:[1,0,3,2] row_mask:0xf bank_mask:0xf
  v_dot2c_f32_bf16 v13, v46, v34
  v_dot2c_f32_bf16 v13, v47, v35
  v_add_f32_dpp v15, v15, v15 quad_perm:[2,3,0,1] row_mask:0xf bank_mask:0xf
  v_bfe_u32 v6, s52, 5, 16
  v_add_u32 v6, v6, v4
  ds_write_b32 v6, v15
  s_waitcnt vmcnt(9)
  s_cbranch_vccnz L_w88
  s_waitcnt vmcnt(6)
  s_cbranch_scc0 L_w88
  s_waitcnt vmcnt(5)
L_w88:
  buffer_load_dwordx4 v[44:47], v1, s[32:35], s59 offen nt
  v_add_u32 v252, 1, v252
  buffer_store_dword v252, v251, s[84:87], s83 offen
  v_mov_b32 v14, 0
  v_dot2c_f32_bf16 v14, v48, v24
  v_dot2c_f32_bf16 v14, v49, v25
  v_add_f32_dpp v15, v13, v13 row_half_mirror row_mask:0xf bank_mask:0x5
  v_dot2c_f32_bf16 v14, v50, v26
  v_dot2c_f32_bf16 v14, v51, v27
  s_waitcnt vmcnt(10)
  s_cbranch_vccnz L_w89
  s_waitcnt vmcnt(7)
  s_cbranch_scc0 L_w89
  s_waitcnt vmcnt(5)
L_w89:
  buffer_load_dwordx4 v[48:51], v2, s[32:35], s59 offen nt
  s_waitcnt lgkmcnt(0)
  v_cmp_lt_u32 s[80:81], v252, v23
  v_cmp_lt_u32 vcc, v252, v22
  ds_read_b64 v[22:23], v250
  s_cmp_lg_u64 s[80:81], 0
  v_mov_b32 v13, 0
  v_add_f32_dpp v15, v14, v14 row_half_mirror row_mask:0xf bank_mask:0xa
  v_dot2c_f32_bf16 v13, v52, v28
  v_dot2c_f32_bf16 v13, v53, v29
  v_add_f32_dpp v15, v15, v15 quad_perm:[1,0,3,2] row_mask:0xf bank_mask:0xf
  v_dot2c_f32_bf16 v13, v54, v30
  v_dot2c_f32_bf16 v13, v55, v31
  v_add_f32_dpp v15, v15, v15 quad_perm:[2,3,0,1] row_mask:0xf bank_mask:0xf
  v_bfe_u32 v6, s53, 5, 16
  v_add_u32 v6, v6, v4
  ds_write_b32 v6, v15
  s_waitcnt vmcnt(9)
  s_cbranch_vccnz L_w90
  s_waitcnt vmcnt(6)
  s_cbranch_scc0 L_w90
  s_waitcnt vmcnt(5)
L_w90:
  buffer_load_dwordx4 v[52:55], v1, s[32:35], s60 offen nt
  v_add_u32 v252, 1, v252
  buffer_store_dword v252, v251, s[84:87], s83 offen
  v_mov_b32 v14, 0
  v_dot2c_f32_bf16 v14, v56, v32
  v_dot2c_f32_bf16 v14, v57, v33
  v_add_f32_dpp v15, v13, v13 row_half_mirror row_mask:0xf bank_mask:0x5
  v_dot2c_f32_bf16 v14, v58, v34
  v_dot2c_f32_bf16 v14, v59, v35
  s_waitcnt vmcnt(10)
  s_cbranch_vccnz L_w91
  s_waitcnt vmcnt(7)
  s_cbranch_scc0 L_w91
  s_waitcnt vmcnt(5)
L_w91:
  buffer_load_dwordx4 v[56:59], v2, s[32:35], s60 offen nt
  s_waitcnt lgkmcnt(0)
  v_cmp_lt_u32 s[80:81], v252, v23
  v_cmp_lt_u32 vcc, v252, v22
  ds_read_b64 v[22:23], v250
  s_cmp_lg_u64 s[80:81], 0
  v_mov_b32 v13, 0
  v_add_f32_dpp v15, v14, v14 row_half_mirror row_mask:0xf bank_mask:0xa
  v_dot2c_f32_bf16 v13, v60, v24
  v_dot2c_f32_bf16 v13, v61, v25
  v_add_f32_dpp v15, v15, v15 quad_perm:[1,0,3,2] row_mask:0xf bank_mask:0xf
  v_dot2c_f32_bf16 v13, v62, v26
  v_dot2c_f32_bf16 v13, v63, v27
  v_add_f32_dpp v15, v15, v15 quad_perm:[2,3,0,1] row_mask:0xf bank_mask:0xf
  v_bfe_u32 v6, s54, 5, 16
  v_add_u32 v6, v6, v4
  ds_write_b32 v6, v15
  s_waitcnt vmcnt(9)
  s_cbranch_vccnz L_w92
  s_waitcnt vmcnt(6)
  s_cbranch_scc0 L_w92
  s_waitcnt vmcnt(5)
L_w92:
  buffer_load_dwordx4 v[60:63], v1, s[32:35], s61 offen nt
  v_add_u32 v252, 1, v252
  buffer_store_dword v252, v251, s[84:87], s83 offen
  v_mov_b32 v14, 0
  v_dot2c_f32_bf16 v14, v64, v28
  v_dot2c_f32_bf16 v14, v65, v29
  v_add_f32_dpp v15, v13, v13 row_half_mirror row_mask:0xf bank_mask:0x5
  v_dot2c_f32_bf16 v14, v66, v30
  v_dot2c_f32_bf16 v14, v67, v31
  s_waitcnt vmcnt(10)
  s_cbranch_vccnz L_w93
  s_waitcnt vmcnt(7)
  s_cbranch_scc0 L_w93
  s_waitcnt vmcnt(5)
L_w93:
  buffer_load_dwordx4 v[64:67], v2, s[32:35], s61 offen nt
  s_waitcnt lgkmcnt(0)
  v_cmp_lt_u32 s[80:81], v252, v23
  v_cmp_lt_u32 vcc, v252, v22
  ds_read_b64 v[22:23], v250
  s_cmp_lg_u64 s[80:81], 0
  v_mov_b32 v13, 0
  v_add_f32_dpp v15, v14, v14 row_half_mirror row_mask:0xf bank_mask:0xa
  v_dot2c_f32_bf16 v13, v68, v32
  v_dot2c_f32_bf16 v13, v69, v33
  v_add_f32_dpp v15, v15, v15 quad_perm:[1,0,3,2] row_mask:0xf bank_mask:0xf
  v_dot2c_f32_bf16 v13, v70, v34
  v_dot2c_f32_bf16 v13, v71, v35
  v_add_f32_dpp v15, v15, v15 quad_perm:[2,3,0,1] row_mask:0xf bank_mask:0xf
  v_bfe_u32 v6, s55, 5, 16
  v_add_u32 v6, v6, v4
  ds_write_b32 v6, v15
  s_waitcnt vmcnt(9)
  s_cbranch_vccnz L_w94
  s_waitcnt vmcnt(6)
  s_cbranch_scc0 L_w94
  s_waitcnt vmcnt(5)
L_w94:
  buffer_load_dwordx4 v[68:71], v1, s[32:35], s62 offen nt
  v_add_u32 v252, 1, v252
  buffer_store_dword v252, v251, s[84:87], s83 offen
  v_mov_b32 v14, 0
  v_dot2c_f32_bf16 v14, v72, v24
  v_dot2c_f32_bf16 v14, v73, v25
  v_add_f32_dpp v15, v13, v13 row_half_mirror row_mask:0xf bank_mask:0x5
  v_dot2c_f32_bf16 v14, v74, v26
  v_dot2c_f32_bf16 v14, v75, v27
  s_waitcnt vmcnt(10)
  s_cbranch_vccnz L_w95
  s_waitcnt vmcnt(7)
  s_cbranch_scc0 L_w95
  s_waitcnt vmcnt(5)
L_w95:
  buffer_load_dwordx4 v[72:75], v2, s[32:35], s62 offen nt
  s_waitcnt lgkmcnt(0)
  v_cmp_lt_u32 s[80:81], v252, v23
  v_cmp_lt_u32 vcc, v252, v22
  ds_read_b64 v[22:23], v250
  s_cmp_lg_u64 s[80:81], 0
  v_mov_b32 v13, 0
  v_add_f32_dpp v15, v14, v14 row_half_mirror row_mask:0xf bank_mask:0xa
  v_dot2c_f32_bf16 v13, v76, v28
  v_dot2c_f32_bf16 v13, v77, v29
  v_add_f32_dpp v15, v15, v15 quad_perm:[1,0,3,2] row_mask:0xf bank_mask:0xf
  v_dot2c_f32_bf16 v13, v78, v30
  v_dot2c_f32_bf16 v13, v79, v31
  v_add_f32_dpp v15, v15, v15 quad_perm:[2,3,0,1] row_mask:0xf bank_mask:0xf
  v_bfe_u32 v6, s56, 5, 16
  v_add_u32 v6, v6, v4
  ds_write_b32 v6, v15
  s_waitcnt vmcnt(9)
  s_cbranch_vccnz L_w96
  s_waitcnt vmcnt(6)
  s_cbranch_scc0 L_w96
  s_waitcnt vmcnt(5)
L_w96:
  buffer_load_dwordx4 v[76:79], v1, s[32:35], s63 offen nt
  v_add_u32 v252, 1, v252
  buffer_store_dword v252, v251, s[84:87], s83 offen
  v_mov_b32 v14, 0
  v_dot2c_f32_bf16 v14, v80, v32
  v_dot2c_f32_bf16 v14, v81, v33
  v_add_f32_dpp v15, v13, v13 row_half_mirror row_mask:0xf bank_mask:0x5
  v_dot2c_f32_bf16 v14, v82, v34
  v_dot2c_f32_bf16 v14, v83, v35
  s_waitcnt vmcnt(10)
  s_cbranch_vccnz L_w97
  s_waitcnt vmcnt(7)
  s_cbranch_scc0 L_w97
  s_waitcnt vmcnt(5)
L_w97:
  buffer_load_dwordx4 v[80:83], v2, s[32:35], s63 offen nt
  s_waitcnt lgkmcnt(0)
  v_cmp_lt_u32 s[80:81], v252, v23
  v_cmp_lt_u32 vcc, v252, v22
  ds_read_b64 v[22:23], v250
  s_cmp_lg_u64 s[80:81], 0
  v_mov_b32 v13, 0
  v_add_f32_dpp v15, v14, v14 row_half_mirror row_mask:0xf bank_mask:0xa
  v_dot2c_f32_bf16 v13, v36, v24
  v_dot2c_f32_bf16 v13, v37, v25
  v_add_f32_dpp v15, v15, v15 quad_perm:[1,0,3,2] row_mask:0xf bank_mask:0xf
  v_dot2c_f32_bf16 v13, v38, v26
  v_dot2c_f32_bf16 v13, v39, v27
  v_add_f32_dpp v15, v15, v15 quad_perm:[2,3,0,1] row_mask:0xf bank_mask:0xf
  v_bfe_u32 v6, s57, 5, 16
  v_add_u32 v6, v6, v4
  ds_write_b32 v6, v15
  s_waitcnt vmcnt(9)
  s_cbranch_vccnz L_w98
  s_waitcnt vmcnt(6)
  s_cbranch_scc0 L_w98
  s_waitcnt vmcnt(5)
L_w98:
  s_add_u32 s32, s32, 50331648
  s_addc_u32 s33, s33, 0
  s_sub_u32 s34, s34, 50331648
  s_cmp_eq_u32 s78, 3
  s_cselect_b32 s32, s68, s32
  s_cselect_b32 s33, s69, s33
  s_cselect_b32 s34, s79, s34
  s_cmp_lg_u64 s[80:81], 0
  buffer_load_dwordx4 v[36:39], v1, s[32:35], s40 offen nt
  v_add_u32 v252, 1, v252
  buffer_store_dword v252, v251, s[84:87], s83 offen
  v_mov_b32 v14, 0
  v_dot2c_f32_bf16 v14, v40, v28
  v_dot2c_f32_bf16 v14, v41, v29
  v_add_f32_dpp v15, v13, v13 row_half_mirror row_mask:0xf bank_mask:0x5
  v_dot2c_f32_bf16 v14, v42, v30
  v_dot2c_f32_bf16 v14, v43, v31
  s_waitcnt vmcnt(10)
  s_cbranch_vccnz L_w99
  s_waitcnt vmcnt(7)
  s_cbranch_scc0 L_w99
  s_waitcnt vmcnt(5)
L_w99:
  buffer_load_dwordx4 v[40:43], v2, s[32:35], s40 offen nt
  s_waitcnt lgkmcnt(0)
  v_cmp_lt_u32 s[80:81], v252, v23
  v_cmp_lt_u32 vcc, v252, v22
  ds_read_b64 v[22:23], v250
  s_cmp_lg_u64 s[80:81], 0
  v_mov_b32 v13, 0
  v_add_f32_dpp v15, v14, v14 row_half_mirror row_mask:0xf bank_mask:0xa
  v_dot2c_f32_bf16 v13, v44, v32
  v_dot2c_f32_bf16 v13, v45, v33
  v_add_f32_dpp v15, v15, v15 quad_perm:[1,0,3,2] row_mask:0xf bank_mask:0xf
  v_dot2c_f32_bf16 v13, v46, v34
  v_dot2c_f32_bf16 v13, v47, v35
  v_add_f32_dpp v15, v15, v15 quad_perm:[2,3,0,1] row_mask:0xf bank_mask:0xf
  v_bfe_u32 v6, s58, 5, 16
  v_add_u32 v6, v6, v4
  ds_write_b32 v6, v15
  s_waitcnt vmcnt(9)
  s_cbranch_vccnz L_w100
  s_waitcnt vmcnt(6)
  s_cbranch_scc0 L_w100
  s_waitcnt vmcnt(5)
L_w100:
  buffer_load_dwordx4 v[44:47], v1, s[32:35], s41 offen nt
  v_add_u32 v252, 1, v252
  buffer_store_dword v252, v251, s[84:87], s83 offen
  v_mov_b32 v14, 0
  v_dot2c_f32_bf16 v14, v48, v24
  v_dot2c_f32_bf16 v14, v49, v25
  v_add_f32_dpp v15, v13, v13 row_half_mirror row_mask:0xf bank_mask:0x5
  v_dot2c_f32_bf16 v14, v50, v26
  v_dot2c_f32_bf16 v14, v51, v27
  s_waitcnt vmcnt(10)
  s_cbranch_vccnz L_w101
  s_waitcnt vmcnt(7)
  s_cbranch_scc0 L_w101
  s_waitcnt vmcnt(5)
L_w101:
  buffer_load_dwordx4 v[48:51], v2, s[32:35], s41 offen nt
  s_waitcnt lgkmcnt(0)
  v_cmp_lt_u32 s[80:81], v252, v23
  v_cmp_lt_u32 vcc, v252, v22
  ds_read_b64 v[22:23], v250
  s_cmp_lg_u64 s[80:81], 0
  v_mov_b32 v13, 0
  v_add_f32_dpp v15, v14, v14 row_half_mirror row_mask:0xf bank_mask:0xa
  v_dot2c_f32_bf16 v13, v52, v28
  v_dot2c_f32_bf16 v13, v53, v29
  v_add_f32_dpp v15, v15, v15 quad_perm:[1,0,3,2] row_mask:0xf bank_mask:0xf
  v_dot2c_f32_bf16 v13, v54, v30
  v_dot2c_f32_bf16 v13, v55, v31
  v_add_f32_dpp v15, v15, v15 quad_perm:[2,3,0,1] row_mask:0xf bank_mask:0xf
  v_bfe_u32 v6, s59, 5, 16
  v_add_u32 v6, v6, v4
  ds_write_b32 v6, v15
  s_waitcnt vmcnt(9)
  s_cbranch_vccnz L_w102
  s_waitcnt vmcnt(6)
  s_cbranch_scc0 L_w102
  s_waitcnt vmcnt(5)
L_w102:
  buffer_load_dwordx4 v[52:55], v1, s[32:35], s42 offen nt
  v_add_u32 v252, 1, v252
  buffer_store_dword v252, v251, s[84:87], s83 offen
  v_mov_b32 v14, 0
  v_dot2c_f32_bf16 v14, v56, v32
  v_dot2c_f32_bf16 v14, v57, v33
  v_add_f32_dpp v15, v13, v13 row_half_mirror row_mask:0xf bank_mask:0x5
  v_dot2c_f32_bf16 v14, v58, v34
  v_dot2c_f32_bf16 v14, v59, v35
  s_waitcnt vmcnt(10)
  s_cbranch_vccnz L_w103
  s_waitcnt vmcnt(7)
  s_cbranch_scc0 L_w103
  s_waitcnt vmcnt(5)
L_w103:
  buffer_load_dwordx4 v[56:59], v2, s[32:35], s42 offen nt
  s_waitcnt lgkmcnt(0)
  v_cmp_lt_u32 s[80:81], v252, v23
  v_cmp_lt_u32 vcc, v252, v22
  ds_read_b64 v[22:23], v250
  s_cmp_lg_u64 s[80:81], 0
  v_mov_b32 v13, 0
  v_add_f32_dpp v15, v14, v14 row_half_mirror row_mask:0xf bank_mask:0xa
  v_dot2c_f32_bf16 v13, v60, v24
  v_dot2c_f32_bf16 v13, v61, v25
  v_add_f32_dpp v15, v15, v15 quad_perm:[1,0,3,2] row_mask:0xf bank_mask:0xf
  v_dot2c_f32_bf16 v13, v62, v26
  v_dot2c_f32_bf16 v13, v63, v27
  v_add_f32_dpp v15, v15, v15 quad_perm:[2,3,0,1] row_mask:0xf bank_mask:0xf
  v_bfe_u32 v6, s60, 5, 16
  v_add_u32 v6, v6, v4
  ds_write_b32 v6, v15
  s_waitcnt vmcnt(9)
  s_cbranch_vccnz L_w104
  s_waitcnt vmcnt(6)
  s_cbranch_scc0 L_w104
  s_waitcnt vmcnt(5)
L_w104:
  buffer_load_dwordx4 v[60:63], v1, s[32:35], s43 offen nt
  v_add_u32 v252, 1, v252
  buffer_store_dword v252, v251, s[84:87], s83 offen
  v_mov_b32 v14, 0
  v_dot2c_f32_bf16 v14, v64, v28
  v_dot2c_f32_bf16 v14, v65, v29
  v_add_f32_dpp v15, v13, v13 row_half_mirror row_mask:0xf bank_mask:0x5
  v_dot2c_f32_bf16 v14, v66, v30
  v_dot2c_f32_bf16 v14, v67, v31
  s_waitcnt vmcnt(10)
  s_cbranch_vccnz L_w105
  s_waitcnt vmcnt(7)
  s_cbranch_scc0 L_w105
  s_waitcnt vmcnt(5)
L_w105:
  buffer_load_dwordx4 v[64:67], v2, s[32:35], s43 offen nt
  s_waitcnt lgkmcnt(0)
  v_cmp_lt_u32 s[80:81], v252, v23
  v_cmp_lt_u32 vcc, v252, v22
  ds_read_b64 v[22:23], v250
  s_cmp_lg_u64 s[80:81], 0
  v_mov_b32 v13, 0
  v_add_f32_dpp v15, v14, v14 row_half_mirror row_mask:0xf bank_mask:0xa
  v_dot2c_f32_bf16 v13, v68, v32
  v_dot2c_f32_bf16 v13, v69, v33
  v_add_f32_dpp v15, v15, v15 quad_perm:[1,0,3,2] row_mask:0xf bank_mask:0xf
  v_dot2c_f32_bf16 v13, v70, v34
  v_dot2c_f32_bf16 v13, v71, v35
  v_add_f32_dpp v15, v15, v15 quad_perm:[2,3,0,1] row_mask:0xf bank_mask:0xf
  v_bfe_u32 v6, s61, 5, 16
  v_add_u32 v6, v6, v4
  ds_write_b32 v6, v15
  s_waitcnt vmcnt(9)
  s_cbranch_vccnz L_w106
  s_waitcnt vmcnt(6)
  s_cbranch_scc0 L_w106
  s_waitcnt vmcnt(5)
L_w106:
  buffer_load_dwordx4 v[68:71], v1, s[32:35], s44 offen nt
  v_add_u32 v252, 1, v252
  buffer_store_dword v252, v251, s[84:87], s83 offen
  v_mov_b32 v14, 0
  v_dot2c_f32_bf16 v14, v72, v24
  v_dot2c_f32_bf16 v14, v73, v25
  v_add_f32_dpp v15, v13, v13 row_half_mirror row_mask:0xf bank_mask:0x5
  v_dot2c_f32_bf16 v14, v74, v26
  v_dot2c_f32_bf16 v14, v75, v27
  s_waitcnt vmcnt(10)
  s_cbranch_vccnz L_w107
  s_waitcnt vmcnt(7)
  s_cbranch_scc0 L_w107
  s_waitcnt vmcnt(5)
L_w107:
  buffer_load_dwordx4 v[72:75], v2, s[32:35], s44 offen nt
  s_waitcnt lgkmcnt(0)
  v_cmp_lt_u32 s[80:81], v252, v23
  v_cmp_lt_u32 vcc, v252, v22
  ds_read_b64 v[22:23], v250
  s_cmp_lg_u64 s[80:81], 0
  v_mov_b32 v13, 0
  v_add_f32_dpp v15, v14, v14 row_half_mirror row_mask:0xf bank_mask:0xa
  v_dot2c_f32_bf16 v13, v76, v28
  v_dot2c_f32_bf16 v13, v77, v29
  v_add_f32_dpp v15, v15, v15 quad_perm:[1,0,3,2] row_mask:0xf bank_mask:0xf
  v_dot2c_f32_bf16 v13, v78, v30
  v_dot2c_f32_bf16 v13, v79, v31
  v_add_f32_dpp v15, v15, v15 quad_perm:[2,3,0,1] row_mask:0xf bank_mask:0xf
  v_bfe_u32 v6, s62, 5, 16
  v_add_u32 v6, v6, v4
  ds_write_b32 v6, v15
  s_waitcnt vmcnt(9)
  buffer_load_dwordx4 v[76:79], v1, s[32:35], s45 offen nt
  v_add_u32 v252, 1, v252
  buffer_store_dword v252, v251, s[84:87], s83 offen
  v_mov_b32 v14, 0
  v_dot2c_f32_bf16 v14, v80, v32
  v_dot2c_f32_bf16 v14, v81, v33
  v_add_f32_dpp v15, v13, v13 row_half_mirror row_mask:0xf bank_mask:0x5
  v_dot2c_f32_bf16 v14, v82, v34
  v_dot2c_f32_bf16 v14, v83, v35
  ds_read_b128 v[24:27], v7
  ds_read_b128 v[28:31], v8
  ds_read_b128 v[32:35], v9
  v_add_u32 v7, 384, v7
  v_add_u32 v8, 384, v8
  v_add_u32 v9, 384, v9
  v_add_f32_dpp v15, v14, v14 row_half_mirror row_mask:0xf bank_mask:0xa
  s_nop 1
  v_add_f32_dpp v15, v15, v15 quad_perm:[1,0,3,2] row_mask:0xf bank_mask:0xf
  s_nop 1
  v_add_f32_dpp v15, v15, v15 quad_perm:[2,3,0,1] row_mask:0xf bank_mask:0xf
  v_bfe_u32 v6, s63, 5, 16
  v_add_u32 v6, v6, v4
  ds_write_b32 v6, v15
  v_add_u32 v4, 6144, v4
  s_add_u32 s78, s78, 1
  s_waitcnt lgkmcnt(0)
  s_barrier
  s_cmp_lt_u32 s78, 4
  s_cbranch_scc1 L_kloop
L_vloop:
  v_bfe_u32 v6, s40, 5, 16
  v_add_u32 v6, v6, v5
  ds_read2st64_b32 v[18:19], v6 offset0:0 offset1:4
  s_cmp_lg_u64 s[80:81], 0
  s_waitcnt vmcnt(10)
  s_cbranch_vccnz L_w108
  s_waitcnt vmcnt(7)
  s_cbranch_scc0 L_w108
  s_waitcnt vmcnt(5)
L_w108:
  buffer_load_dwordx4 v[80:83], v2, s[32:35], s45 offen nt
  v_mov_b64 v[84:85], 0
  v_mov_b64 v[86:87], 0
  v_mov_b64 v[88:89], 0
  v_mov_b64 v[90:91], 0
  v_mov_b64 v[92:93], 0
  v_mov_b64 v[94:95], 0
  v_mov_b64 v[96:97], 0
  v_mov_b64 v[98:99], 0
  v_mov_b64 v[100:101], 0
  v_mov_b64 v[102:103], 0
  v_mov_b64 v[104:105], 0
  v_mov_b64 v[106:107], 0
  s_waitcnt lgkmcnt(0)
  v_cmp_lt_u32 s[80:81], v252, v23
  v_cmp_lt_u32 vcc, v252, v22
  ds_read_b64 v[22:23], v250
  s_cmp_lg_u64 s[80:81], 0
  v_bfe_u32 v6, s41, 5, 16
  v_add_u32 v6, v6, v5
  ds_read2st64_b32 v[20:21], v6 offset0:0 offset1:4
  v_lshlrev_b32 v16, 16, v18
  v_dot2c_f32_bf16 v84, v36, v18
  v_dot2c_f32_bf16 v86, v37, v18
  v_dot2c_f32_bf16 v88, v38, v18
  v_dot2c_f32_bf16 v90, v39, v18
  v_dot2c_f32_bf16 v85, v36, v16
  v_dot2c_f32_bf16 v87, v37, v16
  v_dot2c_f32_bf16 v89, v38, v16
  v_dot2c_f32_bf16 v91, v39, v16
  s_waitcnt vmcnt(9)
  s_cbranch_vccnz L_w109
  s_waitcnt vmcnt(6)
  s_cbranch_scc0 L_w109
  s_waitcnt vmcnt(5)
L_w109:
  buffer_load_dwordx4 v[36:39], v1, s[32:35], s46 offen nt
  v_add_u32 v252, 1, v252
  buffer_store_dword v252, v251, s[84:87], s83 offen
  v_lshlrev_b32 v16, 16, v19
  v_dot2c_f32_bf16 v92, v40, v19
  v_dot2c_f32_bf16 v94, v41, v19
  v_dot2c_f32_bf16 v96, v42, v19
  v_dot2c_f32_bf16 v98, v43, v19
  v_dot2c_f32_bf16 v93, v40, v16
  v_dot2c_f32_bf16 v95, v41, v16
  v_dot2c_f32_bf16 v97, v42, v16
  v_dot2c_f32_bf16 v99, v43, v16
  s_waitcnt vmcnt(10)
  s_cbranch_vccnz L_w110
  s_waitcnt vmcnt(7)
  s_cbranch_scc0 L_w110
  s_waitcnt vmcnt(5)
L_w110:
  buffer_load_dwordx4 v[40:43], v2, s[32:35], s46 offen nt
  s_waitcnt lgkmcnt(0)
  v_cmp_lt_u32 s[80:81], v252, v23
  v_cmp_lt_u32 vcc, v252, v22
  ds_read_b64 v[22:23], v250
  s_cmp_lg_u64 s[80:81], 0
  v_bfe_u32 v6, s42, 5, 16
  v_add_u32 v6, v6, v5
  ds_read2st64_b32 v[18:19], v6 offset0:0 offset1:4
  v_lshlrev_b32 v16, 16, v20
  v_dot2c_f32_bf16 v100, v44, v20
  v_dot2c_f32_bf16 v102, v45, v20
  v_dot2c_f32_bf16 v104, v46, v20
  v_dot2c_f32_bf16 v106, v47, v20
  v_dot2c_f32_bf16 v101, v44, v16
  v_dot2c_f32_bf16 v103, v45, v16
  v_dot2c_f32_bf16 v105, v46, v16
  v_dot2c_f32_bf16 v107, v47, v16
  s_waitcnt vmcnt(9)
  s_cbranch_vccnz L_w111
  s_waitcnt vmcnt(6)
  s_cbranch_scc0 L_w111
  s_waitcnt vmcnt(5)
L_w111:
  buffer_load_dwordx4 v[44:47], v1, s[32:35], s47 offen nt
  v_add_u32 v252, 1, v252
  buffer_store_dword v252, v251, s[84:87], s83 offen
  v_lshlrev_b32 v16, 16, v21
  v_dot2c_f32_bf16 v84, v48, v21
  v_dot2c_f32_bf16 v86, v49, v21
  v_dot2c_f32_bf16 v88, v50, v21
  v_dot2c_f32_bf16 v90, v51, v21
  v_dot2c_f32_bf16 v85, v48, v16
  v_dot2c_f32_bf16 v87, v49, v16
  v_dot2c_f32_bf16 v89, v50, v16
  v_dot2c_f32_bf16 v91, v51, v16
  s_waitcnt vmcnt(10)
  s_cbranch_vccnz L_w112
  s_waitcnt vmcnt(7)
  s_cbranch_scc0 L_w112
  s_waitcnt vmcnt(5)
L_w112:
  buffer_load_dwordx4 v[48:51], v2, s[32:35], s47 offen nt
  s_waitcnt lgkmcnt(0)
  v_cmp_lt_u32 s[80:81], v252, v23
  v_cmp_lt_u32 vcc, v252, v22
  ds_read_b64 v[22:23], v250
  s_cmp_lg_u64 s[80:81], 0
  v_bfe_u32 v6, s43, 5, 16
  v_add_u32 v6, v6, v5
  ds_read2st64_b32 v[20:21], v6 offset0:0 offset1:4
  v_lshlrev_b32 v16, 16, v18
  v_dot2c_f32_bf16 v92, v52, v18
  v_dot2c_f32_bf16 v94, v53, v18
  v_dot2c_f32_bf16 v96, v54, v18
  v_dot2c_f32_bf16 v98, v55, v18
  v_dot2c_f32_bf16 v93, v52, v16
  v_dot2c_f32_bf16 v95, v53, v16
  v_dot2c_f32_bf16 v97, v54, v16
  v_dot2c_f32_bf16 v99, v55, v16
  s_waitcnt vmcnt(9)
  s_cbranch_vccnz L_w113
  s_waitcnt vmcnt(6)
  s_cbranch_scc0 L_w113
  s_waitcnt vmcnt(5)
L_w113:
  buffer_load_dwordx4 v[52:55], v1, s[32:35], s48 offen nt
  v_add_u32 v252, 1, v252
  buffer_store_dword v252, v251, s[84:87], s83 offen
  v_lshlrev_b32 v16, 16, v19
  v_dot2c_f32_bf16 v100, v56, v19
  v_dot2c_f32_bf16 v102, v57, v19
  v_dot2c_f32_bf16 v104, v58, v19
  v_dot2c_f32_bf16 v106, v59, v19
  v_dot2c_f32_bf16 v101, v56, v16
  v_dot2c_f32_bf16 v103, v57, v16
  v_dot2c_f32_bf16 v105, v58, v16
  v_dot2c_f32_bf16 v107, v59, v16
  s_waitcnt vmcnt(10)
  s_cbranch_vccnz L_w114
  s_waitcnt vmcnt(7)
  s_cbranch_scc0 L_w114
  s_waitcnt vmcnt(5)
L_w114:
  buffer_load_dwordx4 v[56:59], v2, s[32:35], s48 offen nt
  s_waitcnt lgkmcnt(0)
  v_cmp_lt_u32 s[80:81], v252, v23
  v_cmp_lt_u32 vcc, v252, v22
  ds_read_b64 v[22:23], v250
  s_cmp_lg_u64 s[80:81], 0
  v_bfe_u32 v6, s44, 5, 16
  v_add_u32 v6, v6, v5
  ds_read2st64_b32 v[18:19], v6 offset0:0 offset1:4
  v_lshlrev_b32 v16, 16, v20
  v_dot2c_f32_bf16 v84, v60, v20
  v_dot2c_f32_bf16 v86, v61, v20
  v_dot2c_f32_bf16 v88, v62, v20
  v_dot2c_f32_bf16 v90, v63, v20
  v_dot2c_f32_bf16 v85, v60, v16
  v_dot2c_f32_bf16 v87, v61, v16
  v_dot2c_f32_bf16 v89, v62, v16
  v_dot2c_f32_bf16 v91, v63, v16
  s_waitcnt vmcnt(9)
  s_cbranch_vccnz L_w115
  s_waitcnt vmcnt(6)
  s_cbranch_scc0 L_w115
  s_waitcnt vmcnt(5)
L_w115:
  buffer_load_dwordx4 v[60:63], v1, s[32:35], s49 offen nt
  v_add_u32 v252, 1, v252
  buffer_store_dword v252, v251, s[84:87], s83 offen
  v_lshlrev_b32 v16, 16, v21
  v_dot2c_f32_bf16 v92, v64, v21
  v_dot2c_f32_bf16 v94, v65, v21
  v_dot2c_f32_bf16 v96, v66, v21
  v_dot2c_f32_bf16 v98, v67, v21
  v_dot2c_f32_bf16 v93, v64, v16
  v_dot2c_f32_bf16 v95, v65, v16
  v_dot2c_f32_bf16 v97, v66, v16
  v_dot2c_f32_bf16 v99, v67, v16
  s_waitcnt vmcnt(10)
  s_cbranch_vccnz L_w116
  s_waitcnt vmcnt(7)
  s_cbranch_scc0 L_w116
  s_waitcnt vmcnt(5)
L_w116:
  buffer_load_dwordx4 v[64:67], v2, s[32:35], s49 offen nt
  s_waitcnt lgkmcnt(0)
  v_cmp_lt_u32 s[80:81], v252, v23
  v_cmp_lt_u32 vcc, v252, v22
  ds_read_b64 v[22:23], v250
  s_cmp_lg_u64 s[80:81], 0
  v_bfe_u32 v6, s45, 5, 16
  v_add_u32 v6, v6, v5
  ds_read2st64_b32 v[20:21], v6 offset0:0 offset1:4
  v_lshlrev_b32 v16, 16, v18
  v_dot2c_f32_bf16 v100, v68, v18
  v_dot2c_f32_bf16 v102, v69, v18
  v_dot2c_f32_bf16 v104, v70, v18
  v_dot2c_f32_bf16 v106, v71, v18
  v_dot2c_f32_bf16 v101, v68, v16
  v_dot2c_f32_bf16 v103, v69, v16
  v_dot2c_f32_bf16 v105, v70, v16
  v_dot2c_f32_bf16 v107, v71, v16
  s_waitcnt vmcnt(9)
  s_cbranch_vccnz L_w117
  s_waitcnt vmcnt(6)
  s_cbranch_scc0 L_w117
  s_waitcnt vmcnt(5)
L_w117:
  buffer_load_dwordx4 v[68:71], v1, s[32:35], s50 offen nt
  v_add_u32 v252, 1, v252
  buffer_store_dword v252, v251, s[84:87], s83 offen
  v_lshlrev_b32 v16, 16, v19
  v_dot2c_f32_bf16 v84, v72, v19
  v_dot2c_f32_bf16 v86, v73, v19
  v_dot2c_f32_bf16 v88, v74, v19
  v_dot2c_f32_bf16 v90, v75, v19
  v_dot2c_f32_bf16 v85, v72, v16
  v_dot2c_f32_bf16 v87, v73, v16
  v_dot2c_f32_bf16 v89, v74, v16
  v_dot2c_f32_bf16 v91, v75, v16
  s_waitcnt vmcnt(10)
  s_cbranch_vccnz L_w118
  s_waitcnt vmcnt(7)
  s_cbranch_scc0 L_w118
  s_waitcnt vmcnt(5)
L_w118:
  buffer_load_dwordx4 v[72:75], v2, s[32:35], s50 offen nt
  s_waitcnt lgkmcnt(0)
  v_cmp_lt_u32 s[80:81], v252, v23
  v_cmp_lt_u32 vcc, v252, v22
  ds_read_b64 v[22:23], v250
  s_cmp_lg_u64 s[80:81], 0
  v_bfe_u32 v6, s46, 5, 16
  v_add_u32 v6, v6, v5
  ds_read2st64_b32 v[18:19], v6 offset0:0 offset1:4
  v_lshlrev_b32 v16, 16, v20
  v_dot2c_f32_bf16 v92, v76, v20
  v_dot2c_f32_bf16 v94, v77, v20
  v_dot2c_f32_bf16 v96, v78, v20
  v_dot2c_f32_bf16 v98, v79, v20
  v_dot2c_f32_bf16 v93, v76, v16
  v_dot2c_f32_bf16 v95, v77, v16
  v_dot2c_f32_bf16 v97, v78, v16
  v_dot2c_f32_bf16 v99, v79, v16
  s_waitcnt vmcnt(9)
  s_cbranch_vccnz L_w119
  s_waitcnt vmcnt(6)
  s_cbranch_scc0 L_w119
  s_waitcnt vmcnt(5)
L_w119:
  buffer_load_dwordx4 v[76:79], v1, s[32:35], s51 offen nt
  v_add_u32 v252, 1, v252
  buffer_store_dword v252, v251, s[84:87], s83 offen
  v_lshlrev_b32 v16, 16, v21
  v_dot2c_f32_bf16 v100, v80, v21
  v_dot2c_f32_bf16 v102, v81, v21
  v_dot2c_f32_bf16 v104, v82, v21
  v_dot2c_f32_bf16 v106, v83, v21
  v_dot2c_f32_bf16 v101, v80, v16
  v_dot2c_f32_bf16 v103, v81, v16
  v_dot2c_f32_bf16 v105, v82, v16
  v_dot2c_f32_bf16 v107, v83, v16
  s_waitcnt vmcnt(10)
  s_cbranch_vccnz L_w120
  s_waitcnt vmcnt(7)
  s_cbranch_scc0 L_w120
  s_waitcnt vmcnt(5)
L_w120:
  buffer_load_dwordx4 v[80:83], v2, s[32:35], s51 offen nt
  s_waitcnt lgkmcnt(0)
  v_cmp_lt_u32 s[80:81], v252, v23
  v_cmp_lt_u32 vcc, v252, v22
  ds_read_b64 v[22:23], v250
  s_cmp_lg_u64 s[80:81], 0
  v_bfe_u32 v6, s47, 5, 16
  v_add_u32 v6, v6, v5
  ds_read2st64_b32 v[20:21], v6 offset0:0 offset1:4
  v_lshlrev_b32 v16, 16, v18
  v_dot2c_f32_bf16 v84, v36, v18
  v_dot2c_f32_bf16 v86, v37, v18
  v_dot2c_f32_bf16 v88, v38, v18
  v_dot2c_f32_bf16 v90, v39, v18
  v_dot2c_f32_bf16 v85, v36, v16
  v_dot2c_f32_bf16 v87, v37, v16
  v_dot2c_f32_bf16 v89, v38, v16
  v_dot2c_f32_bf16 v91, v39, v16
  s_waitcnt vmcnt(9)
  s_cbranch_vccnz L_w121
  s_waitcnt vmcnt(6)
  s_cbranch_scc0 L_w121
  s_waitcnt vmcnt(5)
L_w121:
  buffer_load_dwordx4 v[36:39], v1, s[32:35], s52 offen nt
  v_add_u32 v252, 1, v252
  buffer_store_dword v252, v251, s[84:87], s83 offen
  v_lshlrev_b32 v16, 16, v19
  v_dot2c_f32_bf16 v92, v40, v19
  v_dot2c_f32_bf16 v94, v41, v19
  v_dot2c_f32_bf16 v96, v42, v19
  v_dot2c_f32_bf16 v98, v43, v19
  v_dot2c_f32_bf16 v93, v40, v16
  v_dot2c_f32_bf16 v95, v41, v16
  v_dot2c_f32_bf16 v97, v42, v16
  v_dot2c_f32_bf16 v99, v43, v16
  s_waitcnt vmcnt(10)
  s_cbranch_vccnz L_w122
  s_waitcnt vmcnt(7)
  s_cbranch_scc0 L_w122
  s_waitcnt vmcnt(5)
L_w122:
  buffer_load_dwordx4 v[40:43], v2, s[32:35], s52 offen nt
  s_waitcnt lgkmcnt(0)
  v_cmp_lt_u32 s[80:81], v252, v23
  v_cmp_lt_u32 vcc, v252, v22
  ds_read_b64 v[22:23], v250
  s_cmp_lg_u64 s[80:81], 0
  v_bfe_u32 v6, s48, 5, 16
  v_add_u32 v6, v6, v5
  ds_read2st64_b32 v[18:19], v6 offset0:0 offset1:4
  v_lshlrev_b32 v16, 16, v20
  v_dot2c_f32_bf16 v100, v44, v20
  v_dot2c_f32_bf16 v102, v45, v20
  v_dot2c_f32_bf16 v104, v46, v20
  v_dot2c_f32_bf16 v106, v47, v20
  v_dot2c_f32_bf16 v101, v44, v16
  v_dot2c_f32_bf16 v103, v45, v16
  v_dot2c_f32_bf16 v105, v46, v16
  v_dot2c_f32_bf16 v107, v47, v16
  s_waitcnt vmcnt(9)
  s_cbranch_vccnz L_w123
  s_waitcnt vmcnt(6)
  s_cbranch_scc0 L_w123
  s_waitcnt vmcnt(5)
L_w123:
  buffer_load_dwordx4 v[44:47], v1, s[32:35], s53 offen nt
  v_add_u32 v252, 1, v252
  buffer_store_dword v252, v251, s[84:87], s83 offen
  v_lshlrev_b32 v16, 16, v21
  v_dot2c_f32_bf16 v84, v48, v21
  v_dot2c_f32_bf16 v86, v49, v21
  v_dot2c_f32_bf16 v88, v50, v21
  v_dot2c_f32_bf16 v90, v51, v21
  v_dot2c_f32_bf16 v85, v48, v16
  v_dot2c_f32_bf16 v87, v49, v16
  v_dot2c_f32_bf16 v89, v50, v16
  v_dot2c_f32_bf16 v91, v51, v16
  s_waitcnt vmcnt(10)
  s_cbranch_vccnz L_w124
  s_waitcnt vmcnt(7)
  s_cbranch_scc0 L_w124
  s_waitcnt vmcnt(5)
L_w124:
  buffer_load_dwordx4 v[48:51], v2, s[32:35], s53 offen nt
  s_waitcnt lgkmcnt(0)
  v_cmp_lt_u32 s[80:81], v252, v23
  v_cmp_lt_u32 vcc, v252, v22
  ds_read_b64 v[22:23], v250
  s_cmp_lg_u64 s[80:81], 0
  v_bfe_u32 v6, s49, 5, 16
  v_add_u32 v6, v6, v5
  ds_read2st64_b32 v[20:21], v6 offset0:0 offset1:4
  v_lshlrev_b32 v16, 16, v18
  v_dot2c_f32_bf16 v92, v52, v18
  v_dot2c_f32_bf16 v94, v53, v18
  v_dot2c_f32_bf16 v96, v54, v18
  v_dot2c_f32_bf16 v98, v55, v18
  v_dot2c_f32_bf16 v93, v52, v16
  v_dot2c_f32_bf16 v95, v53, v16
  v_dot2c_f32_bf16 v97, v54, v16
  v_dot2c_f32_bf16 v99, v55, v16
  s_waitcnt vmcnt(9)
  s_cbranch_vccnz L_w125
  s_waitcnt vmcnt(6)
  s_cbranch_scc0 L_w125
  s_waitcnt vmcnt(5)
L_w125:
  buffer_load_dwordx4 v[52:55], v1, s[32:35], s54 offen nt
  v_add_u32 v252, 1, v252
  buffer_store_dword v252, v251, s[84:87], s83 offen
  v_lshlrev_b32 v16, 16, v19
  v_dot2c_f32_bf16 v100, v56, v19
  v_dot2c_f32_bf16 v102, v57, v19
  v_dot2c_f32_bf16 v104, v58, v19
  v_dot2c_f32_bf16 v106, v59, v19
  v_dot2c_f32_bf16 v101, v56, v16
  v_dot2c_f32_bf16 v103, v57, v16
  v_dot2c_f32_bf16 v105, v58, v16
  v_dot2c_f32_bf16 v107, v59, v16
  s_waitcnt vmcnt(10)
  s_cbranch_vccnz L_w126
  s_waitcnt vmcnt(7)
  s_cbranch_scc0 L_w126
  s_waitcnt vmcnt(5)
L_w126:
  buffer_load_dwordx4 v[56:59], v2, s[32:35], s54 offen nt
  s_waitcnt lgkmcnt(0)
  v_cmp_lt_u32 s[80:81], v252, v23
  v_cmp_lt_u32 vcc, v252, v22
  ds_read_b64 v[22:23], v250
  s_cmp_lg_u64 s[80:81], 0
  v_bfe_u32 v6, s50, 5, 16
  v_add_u32 v6, v6, v5
  ds_read2st64_b32 v[18:19], v6 offset0:0 offset1:4
  v_lshlrev_b32 v16, 16, v20
  v_dot2c_f32_bf16 v84, v60, v20
  v_dot2c_f32_bf16 v86, v61, v20
  v_dot2c_f32_bf16 v88, v62, v20
  v_dot2c_f32_bf16 v90, v63, v20
  v_dot2c_f32_bf16 v85, v60, v16
  v_dot2c_f32_bf16 v87, v61, v16
  v_dot2c_f32_bf16 v89, v62, v16
  v_dot2c_f32_bf16 v91, v63, v16
  s_waitcnt vmcnt(9)
  s_cbranch_vccnz L_w127
  s_waitcnt vmcnt(6)
  s_cbranch_scc0 L_w127
  s_waitcnt vmcnt(5)
L_w127:
  buffer_load_dwordx4 v[60:63], v1, s[32:35], s55 offen nt
  v_add_u32 v252, 1, v252
  buffer_store_dword v252, v251, s[84:87], s83 offen
  v_lshlrev_b32 v16, 16, v21
  v_dot2c_f32_bf16 v92, v64, v21
  v_dot2c_f32_bf16 v94, v65, v21
  v_dot2c_f32_bf16 v96, v66, v21
  v_dot2c_f32_bf16 v98, v67, v21
  v_dot2c_f32_bf16 v93, v64, v16
  v_dot2c_f32_bf16 v95, v65, v16
  v_dot2c_f32_bf16 v97, v66, v16
  v_dot2c_f32_bf16 v99, v67, v16
  s_waitcnt vmcnt(10)
  s_cbranch_vccnz L_w128
  s_waitcnt vmcnt(7)
  s_cbranch_scc0 L_w128
  s_waitcnt vmcnt(5)
L_w128:
  buffer_load_dwordx4 v[64:67], v2, s[32:35], s55 offen nt
  s_waitcnt lgkmcnt(0)
  v_cmp_lt_u32 s[80:81], v252, v23
  v_cmp_lt_u32 vcc, v252, v22
  ds_read_b64 v[22:23], v250
  s_cmp_lg_u64 s[80:81], 0
  v_bfe_u32 v6, s51, 5, 16
  v_add_u32 v6, v6, v5
  ds_read2st64_b32 v[20:21], v6 offset0:0 offset1:4
  v_lshlrev_b32 v16, 16, v18
  v_dot2c_f32_bf16 v100, v68, v18
  v_dot2c_f32_bf16 v102, v69, v18
  v_dot2c_f32_bf16 v104, v70, v18
  v_dot2c_f32_bf16 v106, v71, v18
  v_dot2c_f32_bf16 v101, v68, v16
  v_dot2c_f32_bf16 v103, v69, v16
  v_dot2c_f32_bf16 v105, v70, v16
  v_dot2c_f32_bf16 v107, v71, v16
  s_waitcnt vmcnt(9)
  s_cbranch_vccnz L_w129
  s_waitcnt vmcnt(6)
  s_cbranch_scc0 L_w129
  s_waitcnt vmcnt(5)
L_w129:
  buffer_load_dwordx4 v[68:71], v1, s[32:35], s56 offen nt
  v_add_u32 v252, 1, v252
  buffer_store_dword v252, v251, s[84:87], s83 offen
  v_lshlrev_b32 v16, 16, v19
  v_dot2c_f32_bf16 v84, v72, v19
  v_dot2c_f32_bf16 v86, v73, v19
  v_dot2c_f32_bf16 v88, v74, v19
  v_dot2c_f32_bf16 v90, v75, v19
  v_dot2c_f32_bf16 v85, v72, v16
  v_dot2c_f32_bf16 v87, v73, v16
  v_dot2c_f32_bf16 v89, v74, v16
  v_dot2c_f32_bf16 v91, v75, v16
  s_waitcnt vmcnt(10)
  s_cbranch_vccnz L_w130
  s_waitcnt vmcnt(7)
  s_cbranch_scc0 L_w130
  s_waitcnt vmcnt(5)
L_w130:
  buffer_load_dwordx4 v[72:75], v2, s[32:35], s56 offen nt
  s_waitcnt lgkmcnt(0)
  v_cmp_lt_u32 s[80:81], v252, v23
  v_cmp_lt_u32 vcc, v252, v22
  ds_read_b64 v[22:23], v250
  s_cmp_lg_u64 s[80:81], 0
  v_bfe_u32 v6, s52, 5, 16
  v_add_u32 v6, v6, v5
  ds_read2st64_b32 v[18:19], v6 offset0:0 offset1:4
  v_lshlrev_b32 v16, 16, v20
  v_dot2c_f32_bf16 v92, v76, v20
  v_dot2c_f32_bf16 v94, v77, v20
  v_dot2c_f32_bf16 v96, v78, v20
  v_dot2c_f32_bf16 v98, v79, v20
  v_dot2c_f32_bf16 v93, v76, v16
  v_dot2c_f32_bf16 v95, v77, v16
  v_dot2c_f32_bf16 v97, v78, v16
  v_dot2c_f32_bf16 v99, v79, v16
  s_waitcnt vmcnt(9)
  s_cbranch_vccnz L_w131
  s_waitcnt vmcnt(6)
  s_cbranch_scc0 L_w131
  s_waitcnt vmcnt(5)
L_w131:
  buffer_load_dwordx4 v[76:79], v1, s[32:35], s57 offen nt
  v_add_u32 v252, 1, v252
  buffer_store_dword v252, v251, s[84:87], s83 offen
  v_lshlrev_b32 v16, 16, v21
  v_dot2c_f32_bf16 v100, v80, v21
  v_dot2c_f32_bf16 v102, v81, v21
  v_dot2c_f32_bf16 v104, v82, v21
  v_dot2c_f32_bf16 v106, v83, v21
  v_dot2c_f32_bf16 v101, v80, v16
  v_dot2c_f32_bf16 v103, v81, v16
  v_dot2c_f32_bf16 v105, v82, v16
  v_dot2c_f32_bf16 v107, v83, v16
  s_waitcnt vmcnt(10)
  s_cbranch_vccnz L_w132
  s_waitcnt vmcnt(7)
  s_cbranch_scc0 L_w132
  s_waitcnt vmcnt(5)
L_w132:
  buffer_load_dwordx4 v[80:83], v2, s[32:35], s57 offen nt
  s_waitcnt lgkmcnt(0)
  v_cmp_lt_u32 s[80:81], v252, v23
  v_cmp_lt_u32 vcc, v252, v22
  ds_read_b64 v[22:23], v250
  s_cmp_lg_u64 s[80:81], 0
  v_bfe_u32 v6, s53, 5, 16
  v_add_u32 v6, v6, v5
  ds_read2st64_b32 v[20:21], v6 offset0:0 offset1:4
  v_lshlrev_b32 v16, 16, v18
  v_dot2c_f32_bf16 v84, v36, v18
  v_dot2c_f32_bf16 v86, v37, v18
  v_dot2c_f32_bf16 v88, v38, v18
  v_dot2c_f32_bf16 v90, v39, v18
  v_dot2c_f32_bf16 v85, v36, v16
  v_dot2c_f32_bf16 v87, v37, v16
  v_dot2c_f32_bf16 v89, v38, v16
  v_dot2c_f32_bf16 v91, v39, v16
  s_waitcnt vmcnt(9)
  s_cbranch_vccnz L_w133
  s_waitcnt vmcnt(6)
  s_cbranch_scc0 L_w133
  s_waitcnt vmcnt(5)
L_w133:
  buffer_load_dwordx4 v[36:39], v1, s[32:35], s58 offen nt
  v_add_u32 v252, 1, v252
  buffer_store_dword v252, v251, s[84:87], s83 offen
  v_lshlrev_b32 v16, 16, v19
  v_dot2c_f32_bf16 v92, v40, v19
  v_dot2c_f32_bf16 v94, v41, v19
  v_dot2c_f32_bf16 v96, v42, v19
  v_dot2c_f32_bf16 v98, v43, v19
  v_dot2c_f32_bf16 v93, v40, v16
  v_dot2c_f32_bf16 v95, v41, v16
  v_dot2c_f32_bf16 v97, v42, v16
  v_dot2c_f32_bf16 v99, v43, v16
  s_waitcnt vmcnt(10)
  s_cbranch_vccnz L_w134
  s_waitcnt vmcnt(7)
  s_cbranch_scc0 L_w134
  s_waitcnt vmcnt(5)
L_w134:
  buffer_load_dwordx4 v[40:43], v2, s[32:35], s58 offen nt
  s_waitcnt lgkmcnt(0)
  v_cmp_lt_u32 s[80:81], v252, v23
  v_cmp_lt_u32 vcc, v252, v22
  ds_read_b64 v[22:23], v250
  s_cmp_lg_u64 s[80:81], 0
  v_bfe_u32 v6, s54, 5, 16
  v_add_u32 v6, v6, v5
  ds_read2st64_b32 v[18:19], v6 offset0:0 offset1:4
  v_lshlrev_b32 v16, 16, v20
  v_dot2c_f32_bf16 v100, v44, v20
  v_dot2c_f32_bf16 v102, v45, v20
  v_dot2c_f32_bf16 v104, v46, v20
  v_dot2c_f32_bf16 v106, v47, v20
  v_dot2c_f32_bf16 v101, v44, v16
  v_dot2c_f32_bf16 v103, v45, v16
  v_dot2c_f32_bf16 v105, v46, v16
  v_dot2c_f32_bf16 v107, v47, v16
  s_waitcnt vmcnt(9)
  s_cbranch_vccnz L_w135
  s_waitcnt vmcnt(6)
  s_cbranch_scc0 L_w135
  s_waitcnt vmcnt(5)
L_w135:
  buffer_load_dwordx4 v[44:47], v1, s[32:35], s59 offen nt
  v_add_u32 v252, 1, v252
  buffer_store_dword v252, v251, s[84:87], s83 offen
  v_lshlrev_b32 v16, 16, v21
  v_dot2c_f32_bf16 v84, v48, v21
  v_dot2c_f32_bf16 v86, v49, v21
  v_dot2c_f32_bf16 v88, v50, v21
  v_dot2c_f32_bf16 v90, v51, v21
  v_dot2c_f32_bf16 v85, v48, v16
  v_dot2c_f32_bf16 v87, v49, v16
  v_dot2c_f32_bf16 v89, v50, v16
  v_dot2c_f32_bf16 v91, v51, v16
  s_waitcnt vmcnt(10)
  s_cbranch_vccnz L_w136
  s_waitcnt vmcnt(7)
  s_cbranch_scc0 L_w136
  s_waitcnt vmcnt(5)
L_w136:
  buffer_load_dwordx4 v[48:51], v2, s[32:35], s59 offen nt
  s_waitcnt lgkmcnt(0)
  v_cmp_lt_u32 s[80:81], v252, v23
  v_cmp_lt_u32 vcc, v252, v22
  ds_read_b64 v[22:23], v250
  s_cmp_lg_u64 s[80:81], 0
  v_bfe_u32 v6, s55, 5, 16
  v_add_u32 v6, v6, v5
  ds_read2st64_b32 v[20:21], v6 offset0:0 offset1:4
  v_lshlrev_b32 v16, 16, v18
  v_dot2c_f32_bf16 v92, v52, v18
  v_dot2c_f32_bf16 v94, v53, v18
  v_dot2c_f32_bf16 v96, v54, v18
  v_dot2c_f32_bf16 v98, v55, v18
  v_dot2c_f32_bf16 v93, v52, v16
  v_dot2c_f32_bf16 v95, v53, v16
  v_dot2c_f32_bf16 v97, v54, v16
  v_dot2c_f32_bf16 v99, v55, v16
  s_waitcnt vmcnt(9)
  s_cbranch_vccnz L_w137
  s_waitcnt vmcnt(6)
  s_cbranch_scc0 L_w137
  s_waitcnt vmcnt(5)
L_w137:
  buffer_load_dwordx4 v[52:55], v1, s[32:35], s60 offen nt
  v_add_u32 v252, 1, v252
  buffer_store_dword v252, v251, s[84:87], s83 offen
  v_lshlrev_b32 v16, 16, v19
  v_dot2c_f32_bf16 v100, v56, v19
  v_dot2c_f32_bf16 v102, v57, v19
  v_dot2c_f32_bf16 v104, v58, v19
  v_dot2c_f32_bf16 v106, v59, v19
  v_dot2c_f32_bf16 v101, v56, v16
  v_dot2c_f32_bf16 v103, v57, v16
  v_dot2c_f32_bf16 v105, v58, v16
  v_dot2c_f32_bf16 v107, v59, v16
  s_waitcnt vmcnt(10)
  s_cbranch_vccnz L_w138
  s_waitcnt vmcnt(7)
  s_cbranch_scc0 L_w138
  s_waitcnt vmcnt(5)
L_w138:
  buffer_load_dwordx4 v[56:59], v2, s[32:35], s60 offen nt
  s_waitcnt lgkmcnt(0)
  v_cmp_lt_u32 s[80:81], v252, v23
  v_cmp_lt_u32 vcc, v252, v22
  ds_read_b64 v[22:23], v250
  s_cmp_lg_u64 s[80:81], 0
  v_bfe_u32 v6, s56, 5, 16
  v_add_u32 v6, v6, v5
  ds_read2st64_b32 v[18:19], v6 offset0:0 offset1:4
  v_lshlrev_b32 v16, 16, v20
  v_dot2c_f32_bf16 v84, v60, v20
  v_dot2c_f32_bf16 v86, v61, v20
  v_dot2c_f32_bf16 v88, v62, v20
  v_dot2c_f32_bf16 v90, v63, v20
  v_dot2c_f32_bf16 v85, v60, v16
  v_dot2c_f32_bf16 v87, v61, v16
  v_dot2c_f32_bf16 v89, v62, v16
  v_dot2c_f32_bf16 v91, v63, v16
  s_waitcnt vmcnt(9)
  s_cbranch_vccnz L_w139
  s_waitcnt vmcnt(6)
  s_cbranch_scc0 L_w139
  s_waitcnt vmcnt(5)
L_w139:
  buffer_load_dwordx4 v[60:63], v1, s[32:35], s61 offen nt
  v_add_u32 v252, 1, v252
  buffer_store_dword v252, v251, s[84:87], s83 offen
  v_lshlrev_b32 v16, 16, v21
  v_dot2c_f32_bf16 v92, v64, v21
  v_dot2c_f32_bf16 v94, v65, v21
  v_dot2c_f32_bf16 v96, v66, v21
  v_dot2c_f32_bf16 v98, v67, v21
  v_dot2c_f32_bf16 v93, v64, v16
  v_dot2c_f32_bf16 v95, v65, v16
  v_dot2c_f32_bf16 v97, v66, v16
  v_dot2c_f32_bf16 v99, v67, v16
  s_waitcnt vmcnt(10)
  s_cbranch_vccnz L_w140
  s_waitcnt vmcnt(7)
  s_cbranch_scc0 L_w140
  s_waitcnt vmcnt(5)
L_w140:
  buffer_load_dwordx4 v[64:67], v2, s[32:35], s61 offen nt
  s_waitcnt lgkmcnt(0)
  v_cmp_lt_u32 s[80:81], v252, v23
  v_cmp_lt_u32 vcc, v252, v22
  ds_read_b64 v[22:23], v250
  s_cmp_lg_u64 s[80:81], 0
  v_bfe_u32 v6, s57, 5, 16
  v_add_u32 v6, v6, v5
  ds_read2st64_b32 v[20:21], v6 offset0:0 offset1:4
  v_lshlrev_b32 v16, 16, v18
  v_dot2c_f32_bf16 v100, v68, v18
  v_dot2c_f32_bf16 v102, v69, v18
  v_dot2c_f32_bf16 v104, v70, v18
  v_dot2c_f32_bf16 v106, v71, v18
  v_dot2c_f32_bf16 v101, v68, v16
  v_dot2c_f32_bf16 v103, v69, v16
  v_dot2c_f32_bf16 v105, v70, v16
  v_dot2c_f32_bf16 v107, v71, v16
  s_waitcnt vmcnt(9)
  s_cbranch_vccnz L_w141
  s_waitcnt vmcnt(6)
  s_cbranch_scc0 L_w141
  s_waitcnt vmcnt(5)
L_w141:
  buffer_load_dwordx4 v[68:71], v1, s[32:35], s62 offen nt
  v_add_u32 v252, 1, v252
  buffer_store_dword v252, v251, s[84:87], s83 offen
  v_lshlrev_b32 v16, 16, v19
  v_dot2c_f32_bf16 v84, v72, v19
  v_dot2c_f32_bf16 v86, v73, v19
  v_dot2c_f32_bf16 v88, v74, v19
  v_dot2c_f32_bf16 v90, v75, v19
  v_dot2c_f32_bf16 v85, v72, v16
  v_dot2c_f32_bf16 v87, v73, v16
  v_dot2c_f32_bf16 v89, v74, v16
  v_dot2c_f32_bf16 v91, v75, v16
  s_waitcnt vmcnt(10)
  s_cbranch_vccnz L_w142
  s_waitcnt vmcnt(7)
  s_cbranch_scc0 L_w142
  s_waitcnt vmcnt(5)
L_w142:
  buffer_load_dwordx4 v[72:75], v2, s[32:35], s62 offen nt
  s_waitcnt lgkmcnt(0)
  v_cmp_lt_u32 s[80:81], v252, v23
  v_cmp_lt_u32 vcc, v252, v22
  ds_read_b64 v[22:23], v250
  s_cmp_lg_u64 s[80:81], 0
  v_bfe_u32 v6, s58, 5, 16
  v_add_u32 v6, v6, v5
  ds_read2st64_b32 v[18:19], v6 offset0:0 offset1:4
  v_lshlrev_b32 v16, 16, v20
  v_dot2c_f32_bf16 v92, v76, v20
  v_dot2c_f32_bf16 v94, v77, v20
  v_dot2c_f32_bf16 v96, v78, v20
  v_dot2c_f32_bf16 v98, v79, v20
  v_dot2c_f32_bf16 v93, v76, v16
  v_dot2c_f32_bf16 v95, v77, v16
  v_dot2c_f32_bf16 v97, v78, v16
  v_dot2c_f32_bf16 v99, v79, v16
  s_waitcnt vmcnt(9)
  s_cbranch_vccnz L_w143
  s_waitcnt vmcnt(6)
  s_cbranch_scc0 L_w143
  s_waitcnt vmcnt(5)
L_w143:
  buffer_load_dwordx4 v[76:79], v1, s[32:35], s63 offen nt
  v_add_u32 v252, 1, v252
  buffer_store_dword v252, v251, s[84:87], s83 offen
  v_lshlrev_b32 v16, 16, v21
  v_dot2c_f32_bf16 v100, v80, v21
  v_dot2c_f32_bf16 v102, v81, v21
  v_dot2c_f32_bf16 v104, v82, v21
  v_dot2c_f32_bf16 v106, v83, v21
  v_dot2c_f32_bf16 v101, v80, v16
  v_dot2c_f32_bf16 v103, v81, v16
  v_dot2c_f32_bf16 v105, v82, v16
  v_dot2c_f32_bf16 v107, v83, v16
  s_waitcnt vmcnt(10)
  s_cbranch_vccnz L_w144
  s_waitcnt vmcnt(7)
  s_cbranch_scc0 L_w144
  s_waitcnt vmcnt(5)
L_w144:
  buffer_load_dwordx4 v[80:83], v2, s[32:35], s63 offen nt
  s_waitcnt lgkmcnt(0)
  v_cmp_lt_u32 s[80:81], v252, v23
  v_cmp_lt_u32 vcc, v252, v22
  ds_read_b64 v[22:23], v250
  s_cmp_lg_u64 s[80:81], 0
  v_bfe_u32 v6, s59, 5, 16
  v_add_u32 v6, v6, v5
  ds_read2st64_b32 v[20:21], v6 offset0:0 offset1:4
  v_lshlrev_b32 v16, 16, v18
  v_dot2c_f32_bf16 v84, v36, v18
  v_dot2c_f32_bf16 v86, v37, v18
  v_dot2c_f32_bf16 v88, v38, v18
  v_dot2c_f32_bf16 v90, v39, v18
  v_dot2c_f32_bf16 v85, v36, v16
  v_dot2c_f32_bf16 v87, v37, v16
  v_dot2c_f32_bf16 v89, v38, v16
  v_dot2c_f32_bf16 v91, v39, v16
  s_cmp_eq_u32 s78, 7
  s_cbranch_scc1 L_vlast
  s_cmp_lg_u64 s[80:81], 0
  s_waitcnt vmcnt(9)
  s_cbranch_vccnz L_w145
  s_waitcnt vmcnt(6)
  s_cbranch_scc0 L_w145
  s_waitcnt vmcnt(5)
L_w145:
  s_add_u32 s32, s32, 50331648
  s_addc_u32 s33, s33, 0
  s_sub_u32 s34, s34, 50331648
  s_cmp_lg_u64 s[80:81], 0
  buffer_load_dwordx4 v[36:39], v1, s[32:35], s40 offen nt
  v_add_u32 v252, 1, v252
  buffer_store_dword v252, v251, s[84:87], s83 offen
  v_lshlrev_b32 v16, 16, v19
  v_dot2c_f32_bf16 v92, v40, v19
  v_dot2c_f32_bf16 v94, v41, v19
  v_dot2c_f32_bf16 v96, v42, v19
  v_dot2c_f32_bf16 v98, v43, v19
  v_dot2c_f32_bf16 v93, v40, v16
  v_dot2c_f32_bf16 v95, v41, v16
  v_dot2c_f32_bf16 v97, v42, v16
  v_dot2c_f32_bf16 v99, v43, v16
  s_waitcnt vmcnt(10)
  s_cbranch_vccnz L_w146
  s_waitcnt vmcnt(7)
  s_cbranch_scc0 L_w146
  s_waitcnt vmcnt(5)
L_w146:
  buffer_load_dwordx4 v[40:43], v2, s[32:35], s40 offen nt
  s_waitcnt lgkmcnt(0)
  v_cmp_lt_u32 s[80:81], v252, v23
  v_cmp_lt_u32 vcc, v252, v22
  ds_read_b64 v[22:23], v250
  s_cmp_lg_u64 s[80:81], 0
  v_bfe_u32 v6, s60, 5, 16
  v_add_u32 v6, v6, v5
  ds_read2st64_b32 v[18:19], v6 offset0:0 offset1:4
  v_lshlrev_b32 v16, 16, v20
  v_dot2c_f32_bf16 v100, v44, v20
  v_dot2c_f32_bf16 v102, v45, v20
  v_dot2c_f32_bf16 v104, v46, v20
  v_dot2c_f32_bf16 v106, v47, v20
  v_dot2c_f32_bf16 v101, v44, v16
  v_dot2c_f32_bf16 v103, v45, v16
  v_dot2c_f32_bf16 v105, v46, v16
  v_dot2c_f32_bf16 v107, v47, v16
  s_waitcnt vmcnt(9)
  s_cbranch_vccnz L_w147
  s_waitcnt vmcnt(6)
  s_cbranch_scc0 L_w147
  s_waitcnt vmcnt(5)
L_w147:
  buffer_load_dwordx4 v[44:47], v1, s[32:35], s41 offen nt
  v_add_u32 v252, 1, v252
  buffer_store_dword v252, v251, s[84:87], s83 offen
  v_lshlrev_b32 v16, 16, v21
  v_dot2c_f32_bf16 v84, v48, v21
  v_dot2c_f32_bf16 v86, v49, v21
  v_dot2c_f32_bf16 v88, v50, v21
  v_dot2c_f32_bf16 v90, v51, v21
  v_dot2c_f32_bf16 v85, v48, v16
  v_dot2c_f32_bf16 v87, v49, v16
  v_dot2c_f32_bf16 v89, v50, v16
  v_dot2c_f32_bf16 v91, v51, v16
  s_waitcnt vmcnt(10)
  s_cbranch_vccnz L_w148
  s_waitcnt vmcnt(7)
  s_cbranch_scc0 L_w148
  s_waitcnt vmcnt(5)
L_w148:
  buffer_load_dwordx4 v[48:51], v2, s[32:35], s41 offen nt
  s_waitcnt lgkmcnt(0)
  v_cmp_lt_u32 s[80:81], v252, v23
  v_cmp_lt_u32 vcc, v252, v22
  ds_read_b64 v[22:23], v250
  s_cmp_lg_u64 s[80:81], 0
  v_bfe_u32 v6, s61, 5, 16
  v_add_u32 v6, v6, v5
  ds_read2st64_b32 v[20:21], v6 offset0:0 offset1:4
  v_lshlrev_b32 v16, 16, v18
  v_dot2c_f32_bf16 v92, v52, v18
  v_dot2c_f32_bf16 v94, v53, v18
  v_dot2c_f32_bf16 v96, v54, v18
  v_dot2c_f32_bf16 v98, v55, v18
  v_dot2c_f32_bf16 v93, v52, v16
  v_dot2c_f32_bf16 v95, v53, v16
  v_dot2c_f32_bf16 v97, v54, v16
  v_dot2c_f32_bf16 v99, v55, v16
  s_waitcnt vmcnt(9)
  s_cbranch_vccnz L_w149
  s_waitcnt vmcnt(6)
  s_cbranch_scc0 L_w149
  s_waitcnt vmcnt(5)
L_w149:
  buffer_load_dwordx4 v[52:55], v1, s[32:35], s42 offen nt
  v_add_u32 v252, 1, v252
  buffer_store_dword v252, v251, s[84:87], s83 offen
  v_lshlrev_b32 v16, 16, v19
  v_dot2c_f32_bf16 v100, v56, v19
  v_dot2c_f32_bf16 v102, v57, v19
  v_dot2c_f32_bf16 v104, v58, v19
  v_dot2c_f32_bf16 v106, v59, v19
  v_dot2c_f32_bf16 v101, v56, v16
  v_dot2c_f32_bf16 v103, v57, v16
  v_dot2c_f32_bf16 v105, v58, v16
  v_dot2c_f32_bf16 v107, v59, v16
  s_waitcnt vmcnt(10)
  s_cbranch_vccnz L_w150
  s_waitcnt vmcnt(7)
  s_cbranch_scc0 L_w150
  s_waitcnt vmcnt(5)
L_w150:
  buffer_load_dwordx4 v[56:59], v2, s[32:35], s42 offen nt
  s_waitcnt lgkmcnt(0)
  v_cmp_lt_u32 s[80:81], v252, v23
  v_cmp_lt_u32 vcc, v252, v22
  ds_read_b64 v[22:23], v250
  s_cmp_lg_u64 s[80:81], 0
  v_bfe_u32 v6, s62, 5, 16
  v_add_u32 v6, v6, v5
  ds_read2st64_b32 v[18:19], v6 offset0:0 offset1:4
  v_lshlrev_b32 v16, 16, v20
  v_dot2c_f32_bf16 v84, v60, v20
  v_dot2c_f32_bf16 v86, v61, v20
  v_dot2c_f32_bf16 v88, v62, v20
  v_dot2c_f32_bf16 v90, v63, v20
  v_dot2c_f32_bf16 v85, v60, v16
  v_dot2c_f32_bf16 v87, v61, v16
  v_dot2c_f32_bf16 v89, v62, v16
  v_dot2c_f32_bf16 v91, v63, v16
  s_waitcnt vmcnt(9)
  s_cbranch_vccnz L_w151
  s_waitcnt vmcnt(6)
  s_cbranch_scc0 L_w151
  s_waitcnt vmcnt(5)
L_w151:
  buffer_load_dwordx4 v[60:63], v1, s[32:35], s43 offen nt
  v_add_u32 v252, 1, v252
  buffer_store_dword v252, v251, s[84:87], s83 offen
  v_lshlrev_b32 v16, 16, v21
  v_dot2c_f32_bf16 v92, v64, v21
  v_dot2c_f32_bf16 v94, v65, v21
  v_dot2c_f32_bf16 v96, v66, v21
  v_dot2c_f32_bf16 v98, v67, v21
  v_dot2c_f32_bf16 v93, v64, v16
  v_dot2c_f32_bf16 v95, v65, v16
  v_dot2c_f32_bf16 v97, v66, v16
  v_dot2c_f32_bf16 v99, v67, v16
  s_waitcnt vmcnt(10)
  s_cbranch_vccnz L_w152
  s_waitcnt vmcnt(7)
  s_cbranch_scc0 L_w152
  s_waitcnt vmcnt(5)
L_w152:
  buffer_load_dwordx4 v[64:67], v2, s[32:35], s43 offen nt
  s_waitcnt lgkmcnt(0)
  v_cmp_lt_u32 s[80:81], v252, v23
  v_cmp_lt_u32 vcc, v252, v22
  ds_read_b64 v[22:23], v250
  s_cmp_lg_u64 s[80:81], 0
  v_bfe_u32 v6, s63, 5, 16
  v_add_u32 v6, v6, v5
  ds_read2st64_b32 v[20:21], v6 offset0:0 offset1:4
  v_lshlrev_b32 v16, 16, v18
  v_dot2c_f32_bf16 v100, v68, v18
  v_dot2c_f32_bf16 v102, v69, v18
  v_dot2c_f32_bf16 v104, v70, v18
  v_dot2c_f32_bf16 v106, v71, v18
  v_dot2c_f32_bf16 v101, v68, v16
  v_dot2c_f32_bf16 v103, v69, v16
  v_dot2c_f32_bf16 v105, v70, v16
  v_dot2c_f32_bf16 v107, v71, v16
  s_waitcnt vmcnt(9)
  s_cbranch_vccnz L_w153
  s_waitcnt vmcnt(6)
  s_cbranch_scc0 L_w153
  s_waitcnt vmcnt(5)
L_w153:
  buffer_load_dwordx4 v[68:71], v1, s[32:35], s44 offen nt
  v_add_u32 v252, 1, v252
  buffer_store_dword v252, v251, s[84:87], s83 offen
  v_lshlrev_b32 v16, 16, v19
  v_dot2c_f32_bf16 v84, v72, v19
  v_dot2c_f32_bf16 v86, v73, v19
  v_dot2c_f32_bf16 v88, v74, v19
  v_dot2c_f32_bf16 v90, v75, v19
  v_dot2c_f32_bf16 v85, v72, v16
  v_dot2c_f32_bf16 v87, v73, v16
  v_dot2c_f32_bf16 v89, v74, v16
  v_dot2c_f32_bf16 v91, v75, v16
  s_waitcnt vmcnt(10)
  s_cbranch_vccnz L_w154
  s_waitcnt vmcnt(7)
  s_cbranch_scc0 L_w154
  s_waitcnt vmcnt(5)
L_w154:
  buffer_load_dwordx4 v[72:75], v2, s[32:35], s44 offen nt
  s_waitcnt lgkmcnt(0)
  v_cmp_lt_u32 s[80:81], v252, v23
  v_cmp_lt_u32 vcc, v252, v22
  ds_read_b64 v[22:23], v250
  s_cmp_lg_u64 s[80:81], 0
  v_lshlrev_b32 v16, 16, v20
  v_dot2c_f32_bf16 v92, v76, v20
  v_dot2c_f32_bf16 v94, v77, v20
  v_dot2c_f32_bf16 v96, v78, v20
  v_dot2c_f32_bf16 v98, v79, v20
  v_dot2c_f32_bf16 v93, v76, v16
  v_dot2c_f32_bf16 v95, v77, v16
  v_dot2c_f32_bf16 v97, v78, v16
  v_dot2c_f32_bf16 v99, v79, v16
  s_waitcnt vmcnt(9)
  buffer_load_dwordx4 v[76:79], v1, s[32:35], s45 offen nt
  v_add_u32 v252, 1, v252
  buffer_store_dword v252, v251, s[84:87], s83 offen
  v_lshlrev_b32 v16, 16, v21
  v_dot2c_f32_bf16 v100, v80, v21
  v_dot2c_f32_bf16 v102, v81, v21
  v_dot2c_f32_bf16 v104, v82, v21
  v_dot2c_f32_bf16 v106, v83, v21
  v_dot2c_f32_bf16 v101, v80, v16
  v_dot2c_f32_bf16 v103, v81, v16
  v_dot2c_f32_bf16 v105, v82, v16
  v_dot2c_f32_bf16 v107, v83, v16
  v_permlane32_swap_b32 v84, v88
  v_permlane32_swap_b32 v85, v89
  v_permlane32_swap_b32 v86, v90
  v_permlane32_swap_b32 v87, v91
  v_permlane32_swap_b32 v92, v96
  v_permlane32_swap_b32 v93, v97
  v_permlane32_swap_b32 v94, v98
  v_permlane32_swap_b32 v95, v99
  v_permlane32_swap_b32 v100, v104
  v_permlane32_swap_b32 v101, v105
  v_permlane32_swap_b32 v102, v106
  v_permlane32_swap_b32 v103, v107
  v_pk_add_f32 v[84:85], v[84:85], v[104:105]
  v_pk_add_f32 v[86:87], v[86:87], v[106:107]
  v_pk_add_f32 v[92:93], v[92:93], v[88:89]
  v_pk_add_f32 v[94:95], v[94:95], v[90:91]
  v_pk_add_f32 v[100:101], v[100:101], v[96:97]
  v_pk_add_f32 v[102:103], v[102:103], v[98:99]
  v_permlane16_swap_b32 v84, v86
  v_permlane16_swap_b32 v85, v87
  v_permlane16_swap_b32 v92, v94
  v_permlane16_swap_b32 v93, v95
  v_permlane16_swap_b32 v100, v102
  v_permlane16_swap_b32 v101, v103
  v_pk_add_f32 v[84:85], v[84:85], v[94:95]
  v_pk_add_f32 v[92:93], v[92:93], v[102:103]
  v_pk_add_f32 v[100:101], v[100:101], v[86:87]
  s_nop 1
  v_add_f32_dpp v88, v100, v84 row_ror:8 row_mask:0xf bank_mask:0x3
  v_add_f32_dpp v96, v84, v92 row_ror:8 row_mask:0xf bank_mask:0x3
  v_add_f32_dpp v104, v92, v100 row_ror:8 row_mask:0xf bank_mask:0x3
  v_add_f32_dpp v88, v85, v101 row_ror:8 row_mask:0xf bank_mask:0xc
  v_add_f32_dpp v96, v93, v85 row_ror:8 row_mask:0xf bank_mask:0xc
  v_add_f32_dpp v104, v101, v93 row_ror:8 row_mask:0xf bank_mask:0xc
  ds_write_b32 v10, v88
  ds_write_b32 v11, v96
  ds_write_b32 v12, v104
  v_add_u32 v10, 3072, v10
  v_add_u32 v11, 3072, v11
  v_add_u32 v12, 3072, v12
  v_add_u32 v5, 6144, v5
  s_add_u32 s78, s78, 1
  s_waitcnt lgkmcnt(0)
  s_barrier
  s_branch L_vloop
L_vlast:
  s_waitcnt vmcnt(10)
  s_add_u32 m0, s76, 0
  s_add_u32 s65, s72, 0
  buffer_load_dwordx4 v3, s[36:39], s65 offen nt lds
  s_add_u32 m0, s76, 2048
  s_add_u32 s65, s72, 5120
  buffer_load_dwordx4 v3, s[36:39], s65 offen nt lds
  s_add_u32 m0, s76, 1024
  s_add_u32 s65, s72, 20480
  buffer_load_dwordx4 v3, s[36:39], s65 offen nt lds
  s_add_u32 m0, s76, 3072
  s_add_u32 s65, s72, 25600
  buffer_load_dwordx4 v3, s[36:39], s65 offen nt lds
  v_lshlrev_b32 v16, 16, v19
  v_dot2c_f32_bf16 v92, v40, v19
  v_dot2c_f32_bf16 v94, v41, v19
  v_dot2c_f32_bf16 v96, v42, v19
  v_dot2c_f32_bf16 v98, v43, v19
  v_dot2c_f32_bf16 v93, v40, v16
  v_dot2c_f32_bf16 v95, v41, v16
  v_dot2c_f32_bf16 v97, v42, v16
  v_dot2c_f32_bf16 v99, v43, v16
  s_waitcnt vmcnt(13)
  s_waitcnt lgkmcnt(0)
  v_bfe_u32 v6, s60, 5, 16
  v_add_u32 v6, v6, v5
  ds_read2st64_b32 v[18:19], v6 offset0:0 offset1:4
  v_lshlrev_b32 v16, 16, v20
  v_dot2c_f32_bf16 v100, v44, v20
  v_dot2c_f32_bf16 v102, v45, v20
  v_dot2c_f32_bf16 v104, v46, v20
  v_dot2c_f32_bf16 v106, v47, v20
  v_dot2c_f32_bf16 v101, v44, v16
  v_dot2c_f32_bf16 v103, v45, v16
  v_dot2c_f32_bf16 v105, v46, v16
  v_dot2c_f32_bf16 v107, v47, v16
  s_waitcnt vmcnt(12)
  v_lshlrev_b32 v16, 16, v21
  v_dot2c_f32_bf16 v84, v48, v21
  v_dot2c_f32_bf16 v86, v49, v21
  v_dot2c_f32_bf16 v88, v50, v21
  v_dot2c_f32_bf16 v90, v51, v21
  v_dot2c_f32_bf16 v85, v48, v16
  v_dot2c_f32_bf16 v87, v49, v16
  v_dot2c_f32_bf16 v89, v50, v16
  v_dot2c_f32_bf16 v91, v51, v16
  s_waitcnt vmcnt(11)
  s_waitcnt lgkmcnt(0)
  v_bfe_u32 v6, s61, 5, 16
  v_add_u32 v6, v6, v5
  ds_read2st64_b32 v[20:21], v6 offset0:0 offset1:4
  v_lshlrev_b32 v16, 16, v18
  v_dot2c_f32_bf16 v92, v52, v18
  v_dot2c_f32_bf16 v94, v53, v18
  v_dot2c_f32_bf16 v96, v54, v18
  v_dot2c_f32_bf16 v98, v55, v18
  v_dot2c_f32_bf16 v93, v52, v16
  v_dot2c_f32_bf16 v95, v53, v16
  v_dot2c_f32_bf16 v97, v54, v16
  v_dot2c_f32_bf16 v99, v55, v16
  s_waitcnt vmcnt(10)
  v_lshlrev_b32 v16, 16, v19
  v_dot2c_f32_bf16 v100, v56, v19
  v_dot2c_f32_bf16 v102, v57, v19
  v_dot2c_f32_bf16 v104, v58, v19
  v_dot2c_f32_bf16 v106, v59, v19
  v_dot2c_f32_bf16 v101, v56, v16
  v_dot2c_f32_bf16 v103, v57, v16
  v_dot2c_f32_bf16 v105, v58, v16
  v_dot2c_f32_bf16 v107, v59, v16
  s_waitcnt vmcnt(9)
  s_waitcnt lgkmcnt(0)
  v_bfe_u32 v6, s62, 5, 16
  v_add_u32 v6, v6, v5
  ds_read2st64_b32 v[18:19], v6 offset0:0 offset1:4
  v_lshlrev_b32 v16, 16, v20
  v_dot2c_f32_bf16 v84, v60, v20
  v_dot2c_f32_bf16 v86, v61, v20
  v_dot2c_f32_bf16 v88, v62, v20
  v_dot2c_f32_bf16 v90, v63, v20
  v_dot2c_f32_bf16 v85, v60, v16
  v_dot2c_f32_bf16 v87, v61, v16
  v_dot2c_f32_bf16 v89, v62, v16
  v_dot2c_f32_bf16 v91, v63, v16
  s_waitcnt vmcnt(8)
  s_add_u32 m0, s76, 4096
  s_add_u32 s65, s72, 40960
  buffer_load_dwordx4 v3, s[36:39], s65 offen nt lds
  s_add_u32 m0, s76, 6144
  s_add_u32 s65, s72, 46080
  buffer_load_dwordx4 v3, s[36:39], s65 offen nt lds
  v_lshlrev_b32 v16, 16, v21
  v_dot2c_f32_bf16 v92, v64, v21
  v_dot2c_f32_bf16 v94, v65, v21
  v_dot2c_f32_bf16 v96, v66, v21
  v_dot2c_f32_bf16 v98, v67, v21
  v_dot2c_f32_bf16 v93, v64, v16
  v_dot2c_f32_bf16 v95, v65, v16
  v_dot2c_f32_bf16 v97, v66, v16
  v_dot2c_f32_bf16 v99, v67, v16
  s_waitcnt vmcnt(9)
  s_add_u32 m0, s76, 5120
  s_add_u32 s65, s72, 61440
  buffer_load_dwordx4 v3, s[36:39], s65 offen nt lds
  s_add_u32 m0, s76, 7168
  s_add_u32 s65, s72, 66560
  buffer_load_dwordx4 v3, s[36:39], s65 offen nt lds
  s_waitcnt lgkmcnt(0)
  v_bfe_u32 v6, s63, 5, 16
  v_add_u32 v6, v6, v5
  ds_read2st64_b32 v[20:21], v6 offset0:0 offset1:4
  v_lshlrev_b32 v16, 16, v18
  v_dot2c_f32_bf16 v100, v68, v18
  v_dot2c_f32_bf16 v102, v69, v18
  v_dot2c_f32_bf16 v104, v70, v18
  v_dot2c_f32_bf16 v106, v71, v18
  v_dot2c_f32_bf16 v101, v68, v16
  v_dot2c_f32_bf16 v103, v69, v16
  v_dot2c_f32_bf16 v105, v70, v16
  v_dot2c_f32_bf16 v107, v71, v16
  s_waitcnt vmcnt(10)
  s_add_u32 m0, s77, 32768
  s_add_u32 s65, s73, 1024
  buffer_load_dwordx4 v3, s[36:39], s65 offen nt lds
  s_add_u32 m0, s77, 34816
  s_add_u32 s65, s73, 6144
  buffer_load_dwordx4 v3, s[36:39], s65 offen nt lds
  v_lshlrev_b32 v16, 16, v19
  v_dot2c_f32_bf16 v84, v72, v19
  v_dot2c_f32_bf16 v86, v73, v19
  v_dot2c_f32_bf16 v88, v74, v19
  v_dot2c_f32_bf16 v90, v75, v19
  v_dot2c_f32_bf16 v85, v72, v16
  v_dot2c_f32_bf16 v87, v73, v16
  v_dot2c_f32_bf16 v89, v74, v16
  v_dot2c_f32_bf16 v91, v75, v16
  s_waitcnt vmcnt(11)
  s_waitcnt lgkmcnt(0)
  v_lshlrev_b32 v16, 16, v20
  v_dot2c_f32_bf16 v92, v76, v20
  v_dot2c_f32_bf16 v94, v77, v20
  v_dot2c_f32_bf16 v96, v78, v20
  v_dot2c_f32_bf16 v98, v79, v20
  v_dot2c_f32_bf16 v93, v76, v16
  v_dot2c_f32_bf16 v95, v77, v16
  v_dot2c_f32_bf16 v97, v78, v16
  v_dot2c_f32_bf16 v99, v79, v16
  s_waitcnt vmcnt(10)
  v_lshlrev_b32 v16, 16, v21
  v_dot2c_f32_bf16 v100, v80, v21
  v_dot2c_f32_bf16 v102, v81, v21
  v_dot2c_f32_bf16 v104, v82, v21
  v_dot2c_f32_bf16 v106, v83, v21
  v_dot2c_f32_bf16 v101, v80, v16
  v_dot2c_f32_bf16 v103, v81, v16
  v_dot2c_f32_bf16 v105, v82, v16
  v_dot2c_f32_bf16 v107, v83, v16
  v_permlane32_swap_b32 v84, v88
  v_permlane32_swap_b32 v85, v89
  v_permlane32_swap_b32 v86, v90
  v_permlane32_swap_b32 v87, v91
  v_permlane32_swap_b32 v92, v96
  v_permlane32_swap_b32 v93, v97
  v_permlane32_swap_b32 v94, v98
  v_permlane32_swap_b32 v95, v99
  v_permlane32_swap_b32 v100, v104
  v_permlane32_swap_b32 v101, v105
  v_permlane32_swap_b32 v102, v106
  v_permlane32_swap_b32 v103, v107
  v_pk_add_f32 v[84:85], v[84:85], v[104:105]
  v_pk_add_f32 v[86:87], v[86:87], v[106:107]
  v_pk_add_f32 v[92:93], v[92:93], v[88:89]
  v_pk_add_f32 v[94:95], v[94:95], v[90:91]
  v_pk_add_f32 v[100:101], v[100:101], v[96:97]
  v_pk_add_f32 v[102:103], v[102:103], v[98:99]
  v_permlane16_swap_b32 v84, v86
  v_permlane16_swap_b32 v85, v87
  v_permlane16_swap_b32 v92, v94
  v_permlane16_swap_b32 v93, v95
  v_permlane16_swap_b32 v100, v102
  v_permlane16_swap_b32 v101, v103
  v_pk_add_f32 v[84:85], v[84:85], v[94:95]
  v_pk_add_f32 v[92:93], v[92:93], v[102:103]
  v_pk_add_f32 v[100:101], v[100:101], v[86:87]
  s_nop 1
  v_add_f32_dpp v88, v100, v84 row_ror:8 row_mask:0xf bank_mask:0x3
  v_add_f32_dpp v96, v84, v92 row_ror:8 row_mask:0xf bank_mask:0x3
  v_add_f32_dpp v104, v92, v100 row_ror:8 row_mask:0xf bank_mask:0x3
  v_add_f32_dpp v88, v85, v101 row_ror:8 row_mask:0xf bank_mask:0xc
  v_add_f32_dpp v96, v93, v85 row_ror:8 row_mask:0xf bank_mask:0xc
  v_add_f32_dpp v104, v101, v93 row_ror:8 row_mask:0xf bank_mask:0xc
  ds_write_b32 v10, v88
  ds_write_b32 v11, v96
  ds_write_b32 v12, v104
  s_waitcnt lgkmcnt(0)
  s_barrier
  s_waitcnt vmcnt(0)
  s_barrier
  s_endpgm
L_end:
  s_endpgm
L_h2:
  v_and_b32 v3, 3, v0
  v_mul_u32_u24 v3, 1280, v3
  v_lshrrev_b32 v6, 4, v0
  v_lshl_add_u32 v3, v6, 4, v3
  s_lshl_b32 s69, s3, 6
  s_add_u32 s69, s69, s60
  s_mov_b32 s40, s4
  s_mov_b32 s41, s5
  s_movk_i32 s42, 5120
  s_mov_b32 s43, 0x20000
  buffer_load_dwordx4 v[16:19], v3, s[40:43], s69 offen offset:0
  buffer_load_dwordx4 v[20:23], v3, s[40:43], s69 offen offset:256
  buffer_load_dwordx4 v[24:27], v3, s[40:43], s69 offen offset:512
  buffer_load_dwordx4 v[28:31], v3, s[40:43], s69 offen offset:768
  buffer_load_dwordx4 v[32:35], v3, s[40:43], s69 offen offset:1024
  s_cmp_lt_u32 s3, 2
  s_cselect_b32 s63, 3, 2
  s_lshl_b32 s63, s63, 8
  s_add_u32 s69, s69, s63
  s_mov_b32 s36, s28
  s_mov_b32 s37, s29
  s_mov_b32 s38, 872448
  s_mov_b32 s39, 0x20000
  v_lshrrev_b32 v12, 2, v0
  v_lshlrev_b32 v12, 7, v12
  v_and_b32 v13, 3, v0
  v_lshl_add_u32 v12, v13, 3, v12
  v_bfe_u32 v13, v0, 3, 2
  v_xor_b32 v14, s3, v13
  v_lshl_add_u32 v15, v14, 5, v12
  v_add_u32 v12, s70, v12
  v_xor_b32 v14, 0, v13
  v_lshl_add_u32 v8, v14, 5, v12
  v_xor_b32 v14, 1, v13
  v_lshl_add_u32 v9, v14, 5, v12
  v_xor_b32 v14, 2, v13
  v_lshl_add_u32 v10, v14, 5, v12
  v_xor_b32 v14, 3, v13
  v_lshl_add_u32 v11, v14, 5, v12
  v_mov_b32 v116, 0
  v_mov_b32 v117, 0
  v_mov_b32 v118, 0
  v_mov_b32 v119, 0
  v_mov_b32 v120, 0
  v_mov_b32 v121, 0
  v_mov_b32 v122, 0
  v_mov_b32 v123, 0
  v_mov_b32 v124, 0
  v_mov_b32 v125, 0
  v_mov_b32 v126, 0
  v_mov_b32 v127, 0
  v_mov_b32 v128, 0
  v_mov_b32 v129, 0
  v_mov_b32 v130, 0
  v_mov_b32 v131, 0
  v_lshlrev_b32 v6, 4, v0
  s_mov_b32 s72, 0xffff
  s_mov_b32 s73, 0
  s_mov_b32 s74, 0xffff0000
  s_mov_b32 s75, 0
  s_mov_b32 s76, 0
  s_mov_b32 s77, 0xffff
  s_mov_b32 s78, 0
  s_mov_b32 s79, 0xffff0000
  s_mov_b32 s50, 0x7060500
  s_mov_b32 s51, 0x7060501
  s_mov_b32 s52, 0x7060502
  s_mov_b32 s53, 0x7060503
  s_mov_b32 s54, 0x0c0c0400
  s_mov_b32 s55, 0x04000c0c
  s_mov_b32 s56, 0xffffff00
  s_mul_i32 s80, s30, 8192
  s_add_u32 s80, s80, 45056
  s_lshl_b32 s82, s30, 10
  s_lshl_b32 s63, s3, 5
  s_add_u32 s82, s82, s63
  s_add_u32 s82, s82, 4096
  v_and_b32 v36, 7, v0
  v_lshlrev_b32 v36, 7, v36
  s_waitcnt lgkmcnt(0)
  s_add_u32 s49, s49, 1
  s_mul_i32 s48, s49, 0x9e3779b1
  s_or_b32 s48, s48, 1
  v_mov_b32 v7, s48
  v_lshlrev_b32 v139, 3, v0
  s_and_b32 s95, s2, 7
  s_lshl_b32 s95, s95, 9
  s_add_u32 s95, s95, 36864
  s_lshr_b32 s60, s2, 3
  v_lshrrev_b32 v12, 1, v0
  v_and_b32 v13, 1, v0
  v_lshlrev_b32 v13, 4, v13
  v_add_u32 v13, 126784, v13
  v_mov_b32 v14, 126848
  v_cmp_eq_u32 vcc, s60, v12
  s_nop 1
  v_cndmask_b32 v140, v14, v13, vcc
  s_getreg_b32 s86, hwreg(HW_REG_XCC_ID, 0, 4)
  s_lshl_b32 s86, s86, 28
  s_bitcmp1_b32 s86, 28
  s_mov_b32 s85, 0x3eb33333
  s_cselect_b32 s85, 0xbe800000, s85
  v_and_b32 v13, 1, v0
  v_cmp_eq_u32 vcc, 1, v13
  s_mul_i32 s61, s49, 0x85ebca6b
  s_mul_i32 s62, s49, 0x27d4eb2f
  v_mov_b32 v12, s61
  v_mov_b32 v13, s62
  v_cndmask_b32 v12, v12, v13, vcc
  v_xor_b32 v12, s86, v12
  v_and_b32 v184, s56, v12
  s_mul_i32 s61, s49, 0xc2b2ae35
  s_mul_i32 s62, s49, 0x165667b1
  v_mov_b32 v12, s61
  v_mov_b32 v13, s62
  v_cndmask_b32 v12, v12, v13, vcc
  v_xor_b32 v12, s86, v12
  v_and_b32 v185, s56, v12
  s_lshr_b32 s61, s60, 3
  s_lshl_b32 s61, s61, 4
  s_lshl_b64 s[100:101], s[72:73], s61
  s_lshl_b32 s60, s60, 1
  s_mov_b32 s84, 0
  s_mov_b32 s81, 199984
  s_and_b32 s6, s2, 7
  s_lshl_b32 s61, s6, 7
  s_add_u32 s61, s61, 40960
  v_mov_b32 v187, s61
  v_lshrrev_b32 v12, 4, v0
  v_lshl_add_u32 v12, v12, 24, v139
  v_add_u32 v189, s61, v12
  s_waitcnt vmcnt(0)
  s_cmp_eq_u32 s58, 0
  s_cbranch_scc1 L_tdone
  ds_read_b64_tr_b16 v[64:65], v8 offset:0
  ds_read_b64_tr_b16 v[66:67], v8 offset:2048
  ds_read_b64_tr_b16 v[68:69], v9 offset:0
  ds_read_b64_tr_b16 v[70:71], v9 offset:2048
  ds_read_b64_tr_b16 v[72:73], v10 offset:0
  ds_read_b64_tr_b16 v[74:75], v10 offset:2048
  ds_read_b64_tr_b16 v[76:77], v11 offset:0
  ds_read_b64_tr_b16 v[78:79], v11 offset:2048
  s_waitcnt lgkmcnt(6)
  v_mfma_f32_16x16x32_bf16 v[116:119], v[16:19], v[64:67], v[116:119]
  s_waitcnt lgkmcnt(4)
  v_mfma_f32_16x16x32_bf16 v[120:123], v[16:19], v[68:71], v[120:123]
  s_waitcnt lgkmcnt(2)
  v_mfma_f32_16x16x32_bf16 v[124:127], v[16:19], v[72:75], v[124:127]
  s_waitcnt lgkmcnt(0)
  v_mfma_f32_16x16x32_bf16 v[128:131], v[16:19], v[76:79], v[128:131]
  ds_read_b64_tr_b16 v[80:81], v8 offset:16384
  ds_read_b64_tr_b16 v[82:83], v8 offset:18432
  ds_read_b64_tr_b16 v[84:85], v9 offset:16384
  ds_read_b64_tr_b16 v[86:87], v9 offset:18432
  ds_read_b64_tr_b16 v[88:89], v10 offset:16384
  ds_read_b64_tr_b16 v[90:91], v10 offset:18432
  ds_read_b64_tr_b16 v[92:93], v11 offset:16384
  ds_read_b64_tr_b16 v[94:95], v11 offset:18432
  s_waitcnt lgkmcnt(6)
  v_mfma_f32_16x16x32_bf16 v[116:119], v[20:23], v[80:83], v[116:119]
  s_waitcnt lgkmcnt(4)
  v_mfma_f32_16x16x32_bf16 v[120:123], v[20:23], v[84:87], v[120:123]
  s_waitcnt lgkmcnt(2)
  v_mfma_f32_16x16x32_bf16 v[124:127], v[20:23], v[88:91], v[124:127]
  s_waitcnt lgkmcnt(0)
  v_mfma_f32_16x16x32_bf16 v[128:131], v[20:23], v[92:95], v[128:131]
  s_add_u32 s63, s3, 8
  s_cmp_lt_u32 s63, s58
  s_cbranch_scc0 L_tdone
  ds_read_b64_tr_b16 v[64:65], v8 offset:32768
  ds_read_b64_tr_b16 v[66:67], v8 offset:34816
  ds_read_b64_tr_b16 v[68:69], v9 offset:32768
  ds_read_b64_tr_b16 v[70:71], v9 offset:34816
  ds_read_b64_tr_b16 v[72:73], v10 offset:32768
  ds_read_b64_tr_b16 v[74:75], v10 offset:34816
  ds_read_b64_tr_b16 v[76:77], v11 offset:32768
  ds_read_b64_tr_b16 v[78:79], v11 offset:34816
  s_waitcnt lgkmcnt(6)
  v_mfma_f32_16x16x32_bf16 v[116:119], v[24:27], v[64:67], v[116:119]
  s_waitcnt lgkmcnt(4)
  v_mfma_f32_16x16x32_bf16 v[120:123], v[24:27], v[68:71], v[120:123]
  s_waitcnt lgkmcnt(2)
  v_mfma_f32_16x16x32_bf16 v[124:127], v[24:27], v[72:75], v[124:127]
  s_waitcnt lgkmcnt(0)
  v_mfma_f32_16x16x32_bf16 v[128:131], v[24:27], v[76:79], v[128:131]
  s_cmp_eq_u32 s58, 20
  s_cbranch_scc0 L_tdone
  ds_read_b64_tr_b16 v[80:81], v8 offset:49152
  ds_read_b64_tr_b16 v[82:83], v8 offset:51200
  ds_read_b64_tr_b16 v[84:85], v9 offset:49152
  ds_read_b64_tr_b16 v[86:87], v9 offset:51200
  ds_read_b64_tr_b16 v[88:89], v10 offset:49152
  ds_read_b64_tr_b16 v[90:91], v10 offset:51200
  ds_read_b64_tr_b16 v[92:93], v11 offset:49152
  ds_read_b64_tr_b16 v[94:95], v11 offset:51200
  s_waitcnt lgkmcnt(6)
  v_mfma_f32_16x16x32_bf16 v[116:119], v[28:31], v[80:83], v[116:119]
  s_waitcnt lgkmcnt(4)
  v_mfma_f32_16x16x32_bf16 v[120:123], v[28:31], v[84:87], v[120:123]
  s_waitcnt lgkmcnt(2)
  v_mfma_f32_16x16x32_bf16 v[124:127], v[28:31], v[88:91], v[124:127]
  s_waitcnt lgkmcnt(0)
  v_mfma_f32_16x16x32_bf16 v[128:131], v[28:31], v[92:95], v[128:131]
  v_add_u32 v8, 0x10000, v8
  v_add_u32 v9, 0x10000, v9
  v_add_u32 v10, 0x10000, v10
  v_add_u32 v11, 0x10000, v11
  ds_read_b64_tr_b16 v[64:65], v8 offset:0
  ds_read_b64_tr_b16 v[66:67], v8 offset:2048
  ds_read_b64_tr_b16 v[68:69], v9 offset:0
  ds_read_b64_tr_b16 v[70:71], v9 offset:2048
  ds_read_b64_tr_b16 v[72:73], v10 offset:0
  ds_read_b64_tr_b16 v[74:75], v10 offset:2048
  ds_read_b64_tr_b16 v[76:77], v11 offset:0
  ds_read_b64_tr_b16 v[78:79], v11 offset:2048
  s_waitcnt lgkmcnt(6)
  v_mfma_f32_16x16x32_bf16 v[116:119], v[32:35], v[64:67], v[116:119]
  s_waitcnt lgkmcnt(4)
  v_mfma_f32_16x16x32_bf16 v[120:123], v[32:35], v[68:71], v[120:123]
  s_waitcnt lgkmcnt(2)
  v_mfma_f32_16x16x32_bf16 v[124:127], v[32:35], v[72:75], v[124:127]
  s_waitcnt lgkmcnt(0)
  v_mfma_f32_16x16x32_bf16 v[128:131], v[32:35], v[76:79], v[128:131]
L_tdone:
  v_mov_b32 v13, 126720
  s_cmp_lg_u32 s58, 0
  s_cbranch_scc0 L_nopart
  s_nop 3
  v_cndmask_b32 v60, v116, v120, s[74:75]
  v_cndmask_b32 v61, v117, v121, s[74:75]
  v_cndmask_b32 v62, v118, v122, s[74:75]
  v_cndmask_b32 v63, v119, v123, s[74:75]
  v_cndmask_b32 v60, v60, v124, s[76:77]
  v_cndmask_b32 v61, v61, v125, s[76:77]
  v_cndmask_b32 v62, v62, v126, s[76:77]
  v_cndmask_b32 v63, v63, v127, s[76:77]
  v_cndmask_b32 v60, v60, v128, s[78:79]
  v_cndmask_b32 v61, v61, v129, s[78:79]
  v_cndmask_b32 v62, v62, v130, s[78:79]
  v_cndmask_b32 v63, v63, v131, s[78:79]
  s_lshl_b32 s63, s3, 10
  s_add_u32 s63, s63, 118784
  v_add_u32 v12, s63, v6
  ds_write_b128 v12, v[60:63]
  v_mov_b32 v14, 1
  s_mov_b64 exec, 1
  ds_add_u32 v13, v14
  s_mov_b64 exec, -1
  s_cmp_eq_u32 s3, 3
  s_cbranch_scc0 L_qgather
L_pw:
  ds_read_b32 v14, v13
  s_waitcnt lgkmcnt(0)
  v_readfirstlane_b32 s63, v14
  s_cmp_eq_u32 s63, 4
  s_cbranch_scc0 L_pw
  v_add_u32 v12, 118784, v6
  ds_read_b128 v[64:67], v12 offset:0
  ds_read_b128 v[68:71], v12 offset:1024
  ds_read_b128 v[72:75], v12 offset:2048
  ds_read_b128 v[76:79], v12 offset:3072
  s_lshl_b32 s62, s31, 10
  s_add_u32 s62, s62, s80
  s_waitcnt lgkmcnt(0)
  v_pk_add_f32 v[64:65], v[64:65], v[68:69]
  v_pk_add_f32 v[66:67], v[66:67], v[70:71]
  v_pk_add_f32 v[72:73], v[72:73], v[76:77]
  v_pk_add_f32 v[74:75], v[74:75], v[78:79]
  v_pk_add_f32 v[60:61], v[64:65], v[72:73]
  v_pk_add_f32 v[62:63], v[66:67], v[74:75]
  v_perm_b32 v60, v60, v7, s50
  v_perm_b32 v61, v61, v7, s51
  v_perm_b32 v62, v62, v7, s52
  v_perm_b32 v63, v63, v7, s53
  buffer_store_dwordx4 v[60:63], v6, s[36:39], s62 offen
L_nopart:
  s_cmp_eq_u32 s3, 3
  s_cbranch_scc0 L_qgather
  s_mov_b32 s87, s62
  s_movk_i32 s71, 64
L_cm:
  buffer_load_dwordx2 v[104:105], v139, s[36:39], s95 offen nt
  s_mov_b32 s61, 0x10000
  s_movk_i32 s62, 0x100
  s_waitcnt vmcnt(0)
  v_sub_u32 v40, v104, v184
  v_sub_u32 v41, v105, v185
  v_add_u32 v42, s61, v40
  v_add_u32 v43, s61, v41
  v_cmp_gt_u32 vcc, s62, v40
  s_nop 1
  v_cndmask_b32 v42, 0, v42, vcc
  v_cmp_gt_u32 vcc, s62, v41
  s_nop 1
  v_cndmask_b32 v43, 0, v43, vcc
  v_add_u32 v42, v42, v43
  s_nop 1
  v_add_u32_dpp v42, v42, v42 quad_perm:[1,0,3,2] row_mask:0xf bank_mask:0xf
  s_nop 1
  v_add_u32_dpp v42, v42, v42 quad_perm:[2,3,0,1] row_mask:0xf bank_mask:0xf
  s_nop 1
  v_add_u32_dpp v42, v42, v42 row_half_mirror row_mask:0xf bank_mask:0xf
  s_nop 1
  v_add_u32_dpp v42, v42, v42 row_mirror row_mask:0xf bank_mask:0xf
  v_mov_b32 v13, v42
  s_nop 1
  v_permlane16_swap_b32 v42, v13
  v_add_u32 v42, v42, v13
  v_mov_b32 v13, v42
  s_nop 1
  v_permlane32_swap_b32 v42, v13
  v_add_u32 v42, v42, v13
  v_lshrrev_b32 v43, 16, v42
  v_and_b32 v42, 0xffff, v42
  v_cvt_f32_u32 v43, v43
  v_cvt_f32_u32 v42, v42
  v_rcp_f32 v43, v43
  v_cvt_f32_u32 v48, v40
  v_cvt_f32_u32 v49, v41
  v_mul_f32 v42, v42, v43
  v_add_f32 v42, s85, v42
  v_cmp_gt_u32 vcc, s62, v40
  v_sub_f32 v48, v42, v48
  s_nop 0
  v_cndmask_b32 v48, 0, v48, vcc
  v_mul_f32 v50, 0x40600000, v48
  v_mul_f32 v51, 0xc0000000, v48
  v_add_f32 v50, 0x40133333, v50
  v_add_f32 v51, 0x40266666, v51
  v_cvt_u32_f32 v50, v50
  v_cvt_u32_f32 v51, v51
  v_min_u32 v50, 32, v50
  v_min_u32 v51, 32, v51
  v_add_u32 v52, v50, v104
  v_add_u32 v53, v51, v104
  v_cmp_le_u32 vcc, 3, v50
  s_nop 1
  v_cndmask_b32 v44, 0, v52, vcc
  v_cmp_le_u32 vcc, 3, v51
  s_nop 1
  v_cndmask_b32 v45, 0, v53, vcc
  v_cmp_gt_u32 vcc, s62, v41
  v_sub_f32 v49, v42, v49
  s_nop 0
  v_cndmask_b32 v49, 0, v49, vcc
  v_mul_f32 v50, 0x40600000, v49
  v_mul_f32 v51, 0xc0000000, v49
  v_add_f32 v50, 0x40133333, v50
  v_add_f32 v51, 0x40266666, v51
  v_cvt_u32_f32 v50, v50
  v_cvt_u32_f32 v51, v51
  v_min_u32 v50, 32, v50
  v_min_u32 v51, 32, v51
  v_add_u32 v52, v50, v105
  v_add_u32 v53, v51, v105
  v_cmp_le_u32 vcc, 3, v50
  s_nop 1
  v_cndmask_b32 v46, 0, v52, vcc
  v_cmp_le_u32 vcc, 3, v51
  s_nop 1
  v_cndmask_b32 v47, 0, v53, vcc
  v_max_u32 v40, v40, v41
  ds_write_b128 v140, v[44:47]
  v_cmp_gt_u32 vcc, s62, v40
  s_nop 1
  v_cndmask_b32 v40, 0, v40, vcc
  s_andn2_b64 s[62:63], s[100:101], vcc
  s_cselect_b32 s84, s84, 1
  v_readlane_b32 s61, v40, s60
  s_sub_u32 s71, s71, 1
  s_cbranch_scc1 L_cm_x
  s_cmp_eq_u32 s84, 1
  s_cselect_b32 s62, 10, 17
  s_cmp_lt_u32 s61, s62
  s_cbranch_scc1 L_cm
L_cm_x:
  s_mov_b32 s62, s87
  v_mov_b32 v13, 126720
  v_mov_b32 v14, s84
  ds_write_b32 v13, v14 offset:4
  s_cmp_eq_u32 s84, 1
  s_cbranch_scc1 L_hw1
  s_cmp_lg_u32 s58, 0
  s_cbranch_scc0 L_hw1
  buffer_store_dwordx4 v[60:63], v6, s[36:39], s62 offen sc1
  s_branch L_hw1
L_qgather:
  s_lshl_b32 s63, s3, 10
  s_add_u32 s63, s63, s80
  s_mov_b32 s71, 200000
L_pq:
  s_cmp_gt_u32 s71, s81
  s_cbranch_scc1 L_pl1
  buffer_load_dwordx4 v[104:107], v6, s[36:39], s63 offen sc1
  buffer_load_dwordx4 v[108:111], v6, s[36:39], s63 offen offset:3072 sc1
  s_branch L_pm1
L_pl1:
  buffer_load_dwordx4 v[104:107], v6, s[36:39], s63 offen nt
  buffer_load_dwordx4 v[108:111], v6, s[36:39], s63 offen offset:3072 nt
L_pm1:
L_pq_c:
  s_waitcnt vmcnt(0)
  v_perm_b32 v112, v105, v104, s54
  v_perm_b32 v113, v107, v106, s55
  v_perm_b32 v114, v109, v108, s54
  v_perm_b32 v115, v111, v110, s55
  v_bitop3_b32 v112, v112, v113, v7 bitop3:0x56
  v_bitop3_b32 v114, v114, v115, v7 bitop3:0x56
  v_or_b32 v112, v112, v114
  v_cmp_ne_u32 vcc, 0, v112
  s_sub_u32 s71, s71, 1
  s_cbranch_scc1 L_pq_x
  s_and_b64 exec, exec, vcc
  s_cbranch_scc1 L_pq
L_pq_x:
  s_mov_b64 exec, -1
  v_and_b32 v104, s56, v104
  v_and_b32 v105, s56, v105
  v_and_b32 v106, s56, v106
  v_and_b32 v107, s56, v107
  v_and_b32 v108, s56, v108
  v_and_b32 v109, s56, v109
  v_and_b32 v110, s56, v110
  v_and_b32 v111, s56, v111
  v_add_f32 v104, v104, v108
  v_add_f32 v105, v105, v109
  v_add_f32 v106, v106, v110
  v_add_f32 v107, v107, v111
  v_cvt_pk_bf16_f32 v104, v104, v105
  v_cvt_pk_bf16_f32 v106, v106, v107
  s_lshl_b32 s63, s3, 7
  s_add_u32 s63, s63, 122880
  v_lshl_add_u32 v12, v0, 1, s63
  ds_write_b16 v12, v104
  ds_write_b16_d16_hi v12, v104 offset:384
  ds_write_b16 v12, v106 offset:768
  ds_write_b16_d16_hi v12, v106 offset:1152
  s_branch L_hb1
L_hw1:
L_hb1:
  s_waitcnt lgkmcnt(0)
  s_barrier
  v_mov_b32 v12, 126720
  ds_read_b32 v14, v12 offset:4
  s_add_u32 s63, s3, 1
  s_mul_i32 s63, s63, 0x20202020
  v_xor_b32 v141, s63, v7
  s_mov_b32 s83, s80
  s_mul_i32 s62, s3, 192
  s_add_u32 s93, s80, s62
  v_and_b32 v12, 15, v0
  v_min_u32 v12, 11, v12
  v_lshrrev_b32 v13, 4, v0
  v_mul_u32_u24 v20, 2048, v13
  v_lshl_add_u32 v20, v12, 4, v20
  v_lshl_add_u32 v21, v12, 2, v13
  s_mul_i32 s63, s3, 96
  s_add_u32 s63, s63, 126144
  v_lshl_add_u32 v143, v21, 1, s63
  s_mul_i32 s63, s3, 576
  s_add_u32 s63, s63, 124416
  v_lshl_add_u32 v21, v21, 1, s63
  s_mul_i32 s63, s3, 3072
  s_add_u32 s63, s63, 106496
  v_add_u32 v22, s63, v6
  v_mov_b32 v12, 1073741824
  v_cmp_gt_u32 vcc, 48, v0
  s_nop 1
  v_cndmask_b32 v23, v12, v6, vcc
  s_mul_i32 s87, s31, 1024
  s_add_u32 s87, s87, s83
  v_and_b32 v37, 3, v0
  v_mul_u32_u24 v37, 576, v37
  v_add_u32 v37, 124416, v37
  v_lshl_add_u32 v132, v13, 4, v37
  v_lshrrev_b32 v38, 5, v0
  v_lshl_add_u32 v37, v38, 7, v37
  v_bfe_u32 v38, v0, 4, 1
  v_lshl_add_u32 v37, v38, 4, v37
  s_and_b32 s61, s31, 3
  s_lshl_b32 s63, s61, 5
  v_add_u32 v134, s63, v37
  s_mul_i32 s62, s30, 8448
  s_lshl_b32 s63, s31, 10
  s_add_u32 s62, s62, s63
  s_add_u32 s62, s62, 307200
  s_lshl_b32 s63, s30, 2
  s_add_u32 s63, s63, s61
  s_mul_i32 s63, s63, 2304
  s_lshr_b32 s61, s31, 2
  s_lshl_b32 s61, s61, 10
  s_add_u32 s63, s63, s61
  s_add_u32 s63, s63, 577536
  v_mov_b32 v37, s62
  v_mov_b32 v38, s63
  v_cndmask_b32 v37, v12, v37, s[72:73]
  v_cndmask_b32 v37, v37, v38, s[74:75]
  v_and_b32 v38, 15, v0
  v_lshl_add_u32 v133, v38, 4, v37
  s_lshl_b32 s88, s3, 8
  s_lshl_b32 s91, s30, 3
  s_add_u32 s91, s91, s31
  s_cmp_lt_u32 s91, 80
  s_cselect_b32 s86, 2, 0
  s_cmp_eq_u32 s3, 0
  s_cselect_b32 s63, 1, 0
  s_cmp_lt_u32 s91, 64
  s_cselect_b32 s86, s63, s86
  s_lshl_b32 s63, s91, 7
  s_mul_i32 s62, s3, 73728
  s_add_u32 s62, s62, 569344
  s_cmp_lt_u32 s91, 64
  s_cselect_b32 s62, 307200, s62
  s_movk_i32 s61, 2304
  s_cselect_b32 s61, 8448, s61
  s_add_u32 s89, s63, s62
  s_lshl_b32 s62, s61, 4
  s_add_u32 s90, s89, s62
  s_lshl_b32 s62, s61, 3
  v_and_b32 v37, 7, v0
  v_lshrrev_b32 v38, 3, v0
  v_mul_u32_u24 v38, s61, v38
  v_lshl_add_u32 v135, v37, 4, v38
  v_add_u32 v142, s62, v135
  v_lshl_add_u32 v136, v13, 3, v37
  v_lshlrev_b32 v136, 2, v136
  v_add_u32 v136, 118784, v136
  s_lshl_b32 s61, s3, 7
  v_add_u32 v137, s61, v136
  v_mul_u32_u24 v138, 1280, v13
  v_lshl_add_u32 v138, v37, 1, v138
  v_and_b32 v38, 9, v0
  v_lshl_add_u32 v138, v38, 16, v138
  s_lshl_b32 s91, s91, 4
  s_add_u32 s92, s3, 4
  s_lshl_b32 s63, s3, 2
  s_add_u32 s63, s63, 126736
  v_mov_b32 v39, s63
  s_mov_b32 s4, s22
  s_mov_b32 s5, s23
  s_mov_b32 s12, s24
  s_mov_b32 s13, s25
  s_movk_i32 s14, 5120
  s_mov_b32 s15, 0x20000
  s_mov_b32 s57, -1
  s_waitcnt lgkmcnt(0)
  v_readfirstlane_b32 s84, v14
  s_cmp_eq_u32 s84, 1
  s_cselect_b32 s81, 199488, -1
  s_branch L_mid
L_hloop:
  s_barrier
  s_mov_b32 s61, 0
  s_cmp_eq_u32 s57, s92
  s_cbranch_scc0 L_noopub
  ds_read_b128 v[64:67], v22 offset:0
  ds_read_b128 v[68:71], v22 offset:768
  ds_read_b128 v[72:75], v22 offset:1536
  ds_read_b128 v[76:79], v22 offset:2304
  ds_read_b32 v19, v39
  s_mov_b32 s61, 4
  s_waitcnt lgkmcnt(0)
  v_pk_add_f32 v[64:65], v[64:65], v[68:69]
  v_pk_add_f32 v[66:67], v[66:67], v[70:71]
  v_pk_add_f32 v[72:73], v[72:73], v[76:77]
  v_pk_add_f32 v[74:75], v[74:75], v[78:79]
  v_pk_add_f32 v[60:61], v[64:65], v[72:73]
  v_pk_add_f32 v[62:63], v[66:67], v[74:75]
  v_pk_mul_f32 v[60:61], v[60:61], v[18:19] op_sel:[0,1] op_sel_hi:[1,1]
  v_pk_mul_f32 v[62:63], v[62:63], v[18:19] op_sel:[0,1] op_sel_hi:[1,1]
  v_perm_b32 v60, v60, v141, s50
  v_perm_b32 v61, v61, v141, s51
  v_perm_b32 v62, v62, v141, s52
  v_perm_b32 v63, v63, v141, s53
  s_cmp_eq_u32 s84, 1
  s_cbranch_scc1 L_gs2
  buffer_store_dwordx4 v[60:63], v23, s[36:39], s87 offen sc1
  s_branch L_gt2
L_gs2:
  buffer_store_dwordx4 v[60:63], v23, s[36:39], s87 offen
L_gt2:
L_noopub:
L_og:
  s_cmp_eq_u32 s61, 0
  s_cbranch_scc1 L_mid
  s_mov_b32 s71, 200000
L_po:
  s_cmp_gt_u32 s71, s81
  s_cbranch_scc1 L_pl3
  buffer_load_dwordx4 v[104:107], v20, s[36:39], s83 offen sc1
  buffer_load_dwordx4 v[108:111], v20, s[36:39], s83 offen offset:1024 sc1
  s_branch L_pm3
L_pl3:
  buffer_load_dwordx4 v[104:107], v20, s[36:39], s83 offen nt
  buffer_load_dwordx4 v[108:111], v20, s[36:39], s83 offen offset:1024 nt
L_pm3:
L_po_c:
  s_waitcnt vmcnt(0)
  v_perm_b32 v112, v105, v104, s54
  v_perm_b32 v113, v107, v106, s55
  v_perm_b32 v114, v109, v108, s54
  v_perm_b32 v115, v111, v110, s55
  v_bitop3_b32 v112, v112, v113, v141 bitop3:0x56
  v_bitop3_b32 v114, v114, v115, v141 bitop3:0x56
  v_or_b32 v112, v112, v114
  v_cmp_ne_u32 vcc, 0, v112
  s_sub_u32 s71, s71, 1
  s_cbranch_scc1 L_po_x
  s_and_b64 exec, exec, vcc
  s_cbranch_scc1 L_po
L_po_x:
  s_mov_b64 exec, -1
  v_and_b32 v104, s56, v104
  v_and_b32 v105, s56, v105
  v_and_b32 v106, s56, v106
  v_and_b32 v107, s56, v107
  v_and_b32 v108, s56, v108
  v_and_b32 v109, s56, v109
  v_and_b32 v110, s56, v110
  v_and_b32 v111, s56, v111
  v_pk_add_f32 v[104:105], v[104:105], v[108:109]
  v_pk_add_f32 v[106:107], v[106:107], v[110:111]
  s_nop 1
  v_permlane32_swap_b32 v104, v106
  v_permlane32_swap_b32 v105, v107
  v_pk_add_f32 v[104:105], v[104:105], v[106:107]
  s_nop 1
  v_permlane16_swap_b32 v104, v105
  v_add_f32 v104, v104, v105
  v_cvt_pk_bf16_f32 v104, v104, v104
  ds_write_b16 v21, v104
  v_add_u32 v21, 96, v21
  s_add_u32 s83, s83, 192
  s_sub_u32 s61, s61, 1
  s_branch L_og2
L_tail:
  s_mov_b32 s71, 200000
  s_mov_b64 exec, 0xfff
  s_cmp_eq_u32 s84, 1
  s_barrier
  ds_read_b128 v[64:67], v22 offset:0
  ds_read_b128 v[68:71], v22 offset:768
  ds_read_b128 v[72:75], v22 offset:1536
  ds_read_b128 v[76:79], v22 offset:2304
  ds_read_b32 v19, v39
  s_waitcnt lgkmcnt(3)
  v_pk_add_f32 v[64:65], v[64:65], v[68:69]
  v_pk_add_f32 v[66:67], v[66:67], v[70:71]
  s_waitcnt lgkmcnt(1)
  v_pk_add_f32 v[72:73], v[72:73], v[76:77]
  v_pk_add_f32 v[74:75], v[74:75], v[78:79]
  v_pk_add_f32 v[60:61], v[64:65], v[72:73]
  v_pk_add_f32 v[62:63], v[66:67], v[74:75]
  s_waitcnt lgkmcnt(0)
  v_pk_mul_f32 v[60:61], v[60:61], v[18:19] op_sel:[0,1] op_sel_hi:[1,1]
  v_pk_mul_f32 v[62:63], v[62:63], v[18:19] op_sel:[0,1] op_sel_hi:[1,1]
  v_perm_b32 v60, v60, v141, s50
  v_perm_b32 v61, v61, v141, s51
  v_perm_b32 v62, v62, v141, s52
  v_perm_b32 v63, v63, v141, s53
  s_cbranch_scc0 L_trem
  buffer_store_dwordx4 v[60:63], v23, s[36:39], s87 offen
  s_mov_b64 exec, -1
  s_waitcnt vmcnt(0)
  buffer_load_dwordx4 v[104:107], v20, s[36:39], s83 offen nt
  buffer_load_dwordx4 v[108:111], v20, s[36:39], s83 offen offset:1024 nt
L_tback:
  ds_read_b128 v[168:171], v132 offset:384
  ds_read_b128 v[172:175], v132 offset:448
  s_barrier
  ds_read_b64_tr_b16 v[64:65], v15 offset:0
  ds_read_b64_tr_b16 v[66:67], v15 offset:2048
  ds_read_b64_tr_b16 v[68:69], v15 offset:4096
  ds_read_b64_tr_b16 v[70:71], v15 offset:6144
  ds_read_b64_tr_b16 v[72:73], v15 offset:8192
  ds_read_b64_tr_b16 v[74:75], v15 offset:10240
  ds_read_b64_tr_b16 v[76:77], v15 offset:12288
  ds_read_b64_tr_b16 v[78:79], v15 offset:14336
  ds_read_b64_tr_b16 v[80:81], v15 offset:16384
  ds_read_b64_tr_b16 v[82:83], v15 offset:18432
  ds_read_b64_tr_b16 v[84:85], v15 offset:20480
  ds_read_b64_tr_b16 v[86:87], v15 offset:22528
  ds_read_b64_tr_b16 v[88:89], v15 offset:24576
  ds_read_b64_tr_b16 v[90:91], v15 offset:26624
  ds_read_b64_tr_b16 v[92:93], v15 offset:28672
  ds_read_b64_tr_b16 v[94:95], v15 offset:30720
  ds_read_b64_tr_b16 v[96:97], v15 offset:32768
  ds_read_b64_tr_b16 v[98:99], v15 offset:34816
  ds_read_b64_tr_b16 v[100:101], v15 offset:36864
  ds_read_b64_tr_b16 v[102:103], v15 offset:38912
L_tchk:
  s_waitcnt vmcnt(1)
  v_perm_b32 v112, v105, v104, s54
  v_perm_b32 v113, v107, v106, s55
  v_bitop3_b32 v112, v112, v113, v141 bitop3:0x56
  s_waitcnt vmcnt(0)
  v_perm_b32 v114, v109, v108, s54
  v_perm_b32 v115, v111, v110, s55
  v_bitop3_b32 v114, v114, v115, v141 bitop3:0x56
  v_or_b32 v112, v112, v114
  v_cmp_ne_u32 vcc, 0, v112
  s_cmp_lg_u64 vcc, 0
  s_cbranch_scc1 L_tagain
L_tok:
  s_mov_b64 exec, -1
  v_and_b32 v104, s56, v104
  v_and_b32 v105, s56, v105
  v_and_b32 v106, s56, v106
  v_and_b32 v107, s56, v107
  v_and_b32 v108, s56, v108
  v_and_b32 v109, s56, v109
  v_and_b32 v110, s56, v110
  v_and_b32 v111, s56, v111
  v_pk_add_f32 v[104:105], v[104:105], v[108:109]
  v_pk_add_f32 v[106:107], v[106:107], v[110:111]
  s_nop 1
  v_permlane32_swap_b32 v104, v106
  v_permlane32_swap_b32 v105, v107
  v_pk_add_f32 v[104:105], v[104:105], v[106:107]
  s_nop 1
  v_permlane16_swap_b32 v104, v105
  v_add_f32 v104, v104, v105
  v_cvt_pk_bf16_f32 v104, v104, v104
  ds_write_b16 v21, v104
  s_waitcnt lgkmcnt(0)
  s_barrier
  ds_read_b128 v[144:147], v132 offset:0
  ds_read_b128 v[148:151], v132 offset:64
  ds_read_b128 v[176:179], v134 offset:0
  ds_read_b128 v[152:155], v132 offset:128
  ds_read_b128 v[156:159], v132 offset:192
  ds_read_b128 v[180:183], v134 offset:256
  ds_read_b128 v[160:163], v132 offset:256
  ds_read_b128 v[164:167], v132 offset:320
  v_mfma_f32_16x16x32_bf16 v[40:43], v[168:171], v[88:91], 0
  v_mfma_f32_16x16x32_bf16 v[44:47], v[172:175], v[92:95], 0
  s_waitcnt lgkmcnt(7)
  v_mfma_f32_16x16x32_bf16 v[40:43], v[144:147], v[64:67], v[40:43]
  s_waitcnt lgkmcnt(6)
  v_mfma_f32_16x16x32_bf16 v[44:47], v[148:151], v[68:71], v[44:47]
  s_waitcnt lgkmcnt(5)
  v_mfma_f32_16x16x32_bf16 v[48:51], v[176:179], v[96:99], 0
  s_waitcnt lgkmcnt(4)
  v_mfma_f32_16x16x32_bf16 v[40:43], v[152:155], v[72:75], v[40:43]
  s_waitcnt lgkmcnt(3)
  v_mfma_f32_16x16x32_bf16 v[44:47], v[156:159], v[76:79], v[44:47]
  s_waitcnt lgkmcnt(2)
  v_mfma_f32_16x16x32_bf16 v[48:51], v[180:183], v[100:103], v[48:51]
  s_waitcnt lgkmcnt(1)
  v_mfma_f32_16x16x32_bf16 v[40:43], v[160:163], v[80:83], v[40:43]
  s_waitcnt lgkmcnt(0)
  v_mfma_f32_16x16x32_bf16 v[44:47], v[164:167], v[84:87], v[44:47]
  s_nop 7
  v_pk_add_f32 v[60:61], v[40:41], v[44:45]
  v_pk_add_f32 v[62:63], v[42:43], v[46:47]
  v_cndmask_b32 v60, v60, v48, s[74:75]
  v_cndmask_b32 v61, v61, v49, s[74:75]
  v_cndmask_b32 v62, v62, v50, s[74:75]
  v_cndmask_b32 v63, v63, v51, s[74:75]
  v_perm_b32 v60, v60, v7, s50
  v_perm_b32 v61, v61, v7, s51
  v_perm_b32 v62, v62, v7, s52
  v_perm_b32 v63, v63, v7, s53
  buffer_store_dwordx4 v[60:63], v133, s[36:39], s88 offen sc1
  s_cmp_eq_u32 s86, 0
  s_cbranch_scc1 L_hend
  s_mov_b32 s71, 200000
  s_waitcnt vmcnt(0)
L_py:
  buffer_load_dwordx4 v[104:107], v135, s[36:39], s89 offen sc1
  buffer_load_dwordx4 v[108:111], v135, s[36:39], s90 offen sc1
  buffer_load_dwordx4 v[64:67], v142, s[36:39], s89 offen sc1
  buffer_load_dwordx4 v[68:71], v142, s[36:39], s90 offen sc1
  s_waitcnt vmcnt(3)
  v_perm_b32 v72, v105, v104, s54
  v_perm_b32 v73, v107, v106, s55
  v_bitop3_b32 v72, v72, v73, v7 bitop3:0x56
  s_waitcnt vmcnt(2)
  v_perm_b32 v74, v109, v108, s54
  v_perm_b32 v75, v111, v110, s55
  v_bitop3_b32 v74, v74, v75, v7 bitop3:0x56
  s_waitcnt vmcnt(1)
  v_perm_b32 v76, v65, v64, s54
  v_perm_b32 v77, v67, v66, s55
  v_bitop3_b32 v76, v76, v77, v7 bitop3:0x56
  s_waitcnt vmcnt(0)
  v_perm_b32 v78, v69, v68, s54
  v_perm_b32 v79, v71, v70, s55
  v_bitop3_b32 v78, v78, v79, v7 bitop3:0x56
  v_or3_b32 v72, v72, v74, v76
  v_or_b32 v72, v72, v78
  v_cmp_ne_u32 vcc, 0, v72
  s_sub_u32 s71, s71, 1
  s_cbranch_scc1 L_py_x
  s_and_b64 exec, exec, vcc
  s_cbranch_scc1 L_py
L_py_x:
  s_mov_b64 exec, -1
  v_and_b32 v104, s56, v104
  v_and_b32 v105, s56, v105
  v_and_b32 v106, s56, v106
  v_and_b32 v107, s56, v107
  v_and_b32 v108, s56, v108
  v_and_b32 v109, s56, v109
  v_and_b32 v110, s56, v110
  v_and_b32 v111, s56, v111
  v_and_b32 v64, s56, v64
  v_and_b32 v65, s56, v65
  v_and_b32 v66, s56, v66
  v_and_b32 v67, s56, v67
  v_and_b32 v68, s56, v68
  v_and_b32 v69, s56, v69
  v_and_b32 v70, s56, v70
  v_and_b32 v71, s56, v71
  v_pk_add_f32 v[104:105], v[104:105], v[64:65]
  v_pk_add_f32 v[106:107], v[106:107], v[66:67]
  v_pk_add_f32 v[108:109], v[108:109], v[68:69]
  v_pk_add_f32 v[110:111], v[110:111], v[70:71]
  v_pk_add_f32 v[104:105], v[104:105], v[108:109]
  v_pk_add_f32 v[106:107], v[106:107], v[110:111]
  s_nop 1
  v_permlane32_swap_b32 v104, v106
  v_permlane32_swap_b32 v105, v107
  v_pk_add_f32 v[104:105], v[104:105], v[106:107]
  s_nop 1
  v_permlane16_swap_b32 v104, v105
  v_add_f32 v104, v104, v105
  s_nop 1
  v_add_f32_dpp v40, v104, v104 row_ror:8 row_mask:0xf bank_mask:0xf
  s_cmp_eq_u32 s86, 1
  s_cbranch_scc1 L_out
  ds_write_b32 v137, v40
  s_waitcnt lgkmcnt(0)
  s_barrier
  s_cmp_eq_u32 s3, 0
  s_cbranch_scc0 L_hend
  ds_read2_b32 v[40:41], v136 offset0:0 offset1:32
  ds_read2_b32 v[42:43], v136 offset0:64 offset1:96
  s_waitcnt lgkmcnt(0)
  v_add_f32 v40, v40, v41
  v_add_f32 v42, v42, v43
  v_add_f32 v40, v40, v42
L_out:
  s_nop 1
  v_mov_b32_dpp v41, v40 quad_perm:[1,0,3,2] row_mask:0xf bank_mask:0xf
  v_cvt_pk_bf16_f32 v40, v40, v41
  buffer_store_dword v40, v138, s[12:15], s91 offen
  s_cmp_eq_u32 s2, 0
  s_cbranch_scc0 L_hend
  v_mov_b32 v42, s49
  v_lshlrev_b32 v43, 2, v0
  buffer_store_dword v42, v43, s[36:39], 0 offen offset:0
L_hend:
  s_endpgm
L_trem:
  buffer_store_dwordx4 v[60:63], v23, s[36:39], s87 offen sc1
  s_mov_b64 exec, -1
  buffer_load_dwordx4 v[104:107], v20, s[36:39], s83 offen sc1
  buffer_load_dwordx4 v[108:111], v20, s[36:39], s83 offen offset:1024 sc1
  s_branch L_tback
L_tagain:
  s_sub_u32 s71, s71, 1
  s_cbranch_scc1 L_tok
  s_mov_b64 exec, vcc
  s_cmp_gt_u32 s71, s81
  s_cbranch_scc1 L_pl4
  buffer_load_dwordx4 v[104:107], v20, s[36:39], s83 offen sc1
  buffer_load_dwordx4 v[108:111], v20, s[36:39], s83 offen offset:1024 sc1
  s_branch L_pm4
L_pl4:
  buffer_load_dwordx4 v[104:107], v20, s[36:39], s83 offen nt
  buffer_load_dwordx4 v[108:111], v20, s[36:39], s83 offen offset:1024 nt
L_pm4:
  s_branch L_tchk
L_og2:
  s_cmp_eq_u32 s61, 0
  s_cbranch_scc1 L_mid
  s_cmp_eq_u32 s61, 3
  s_cbranch_scc0 L_og3
  buffer_load_dwordx4 v[144:147], v20, s[36:39], s83 offen offset:0 nt
  buffer_load_dwordx4 v[148:151], v20, s[36:39], s83 offen offset:1024 nt
  buffer_load_dwordx4 v[152:155], v20, s[36:39], s83 offen offset:192 nt
  buffer_load_dwordx4 v[156:159], v20, s[36:39], s83 offen offset:1216 nt
  buffer_load_dwordx4 v[160:163], v20, s[36:39], s83 offen offset:384 nt
  buffer_load_dwordx4 v[164:167], v20, s[36:39], s83 offen offset:1408 nt
  s_waitcnt vmcnt(0)
L_og3:
  v_mov_b64 v[104:105], v[144:145]
  v_mov_b64 v[106:107], v[146:147]
  v_mov_b64 v[108:109], v[148:149]
  v_mov_b64 v[110:111], v[150:151]
  v_mov_b64 v[144:145], v[152:153]
  v_mov_b64 v[146:147], v[154:155]
  v_mov_b64 v[148:149], v[156:157]
  v_mov_b64 v[150:151], v[158:159]
  v_mov_b64 v[152:153], v[160:161]
  v_mov_b64 v[154:155], v[162:163]
  v_mov_b64 v[156:157], v[164:165]
  v_mov_b64 v[158:159], v[166:167]
  s_mov_b32 s71, 200000
  s_branch L_po_c
L_mid:
  s_cmp_eq_u32 s60, 40
  s_cbranch_scc0 L_noxr
  s_cmp_ge_i32 s57, 4
  s_cbranch_scc0 L_noxr
  s_add_u32 s61, s57, 3
  s_and_b32 s61, s61, 3
  s_cmp_eq_u32 s61, s3
  s_cbranch_scc0 L_noxr
  s_lshl_b32 s61, s57, 5
  s_add_u32 s44, s26, s61
  s_addc_u32 s45, s27, 0
  s_mov_b32 s61, 1
  s_atomic_add s61, s[44:45], 0 glc
  v_mov_b32 v51, v7
  s_waitcnt lgkmcnt(0)
  s_min_u32 s61, s61, 7
  v_cvt_f32_u32 v50, s61
  v_add_f32 v50, 0xc0600000, v50
  v_mul_f32 v50, 0x3e924925, v50
  v_mul_f32 v50, 0x3fa66666, v50
  buffer_store_dwordx2 v[50:51], v189, s[36:39], 0 offen
L_noxr:
  v_mov_b32 v12, 126720
  ds_read_b32 v14, v12 offset:4
  s_waitcnt lgkmcnt(0)
  v_readfirstlane_b32 s84, v14
  s_cmp_eq_u32 s84, 1
  s_cselect_b32 s81, 199488, -1
  s_cmp_eq_u32 s57, s92
  s_cbranch_scc0 L_noack
  v_perm_b32 v60, v60, v7, s50
  v_perm_b32 v61, v61, v7, s51
  v_perm_b32 v62, v62, v7, s52
  v_perm_b32 v63, v63, v7, s53
  v_lshlrev_b32 v12, 24, v0
  s_lshl_b32 s63, s31, 7
  s_add_u32 s63, s63, s82
  s_add_u32 s63, s63, 16
  s_cmp_eq_u32 s84, 1
  s_cbranch_scc1 L_gs5
  buffer_store_dwordx4 v[60:63], v12, s[36:39], s63 offen sc1
  s_branch L_gt5
L_gs5:
  buffer_store_dwordx4 v[60:63], v12, s[36:39], s63 offen
L_gt5:
L_noack:
  s_cmp_eq_u32 s57, s3
  s_cbranch_scc0 L_nosm
  s_mul_i32 s63, s3, 6144
  s_add_u32 s63, s63, 81920
  v_mul_u32_u24 v12, 96, v0
  v_add_u32 v12, s63, v12
  ds_read_b128 v[64:67], v12 offset:0
  ds_read_b128 v[68:71], v12 offset:16
  ds_read_b128 v[72:75], v12 offset:32
  ds_read_b128 v[76:79], v12 offset:48
  ds_read_b128 v[80:83], v12 offset:64
  ds_read_b128 v[84:87], v12 offset:80
  s_mov_b32 s63, 0x3d93cd3a
  s_mov_b32 s62, 0x3fb8aa3b
  s_waitcnt lgkmcnt(0)
  v_add_f32 v40, v64, v65
  v_add_f32 v41, v67, v68
  v_add_f32 v42, v70, v71
  v_add_f32 v43, v73, v74
  v_add_f32 v44, v76, v77
  v_add_f32 v45, v79, v80
  v_add_f32 v46, v82, v83
  v_add_f32 v47, v85, v86
  v_add_f32 v40, v40, v66
  v_add_f32 v41, v41, v69
  v_add_f32 v42, v42, v72
  v_add_f32 v43, v43, v75
  v_add_f32 v44, v44, v78
  v_add_f32 v45, v45, v81
  v_add_f32 v46, v46, v84
  v_add_f32 v47, v47, v87
  v_cvt_pk_bf16_f32 v41, v40, v41
  v_cvt_pk_bf16_f32 v43, v42, v43
  v_cvt_pk_bf16_f32 v45, v44, v45
  v_cvt_pk_bf16_f32 v47, v46, v47
  v_lshlrev_b32 v40, 16, v41
  v_and_b32 v41, 0xffff0000, v41
  v_lshlrev_b32 v42, 16, v43
  v_and_b32 v43, 0xffff0000, v43
  v_lshlrev_b32 v44, 16, v45
  v_and_b32 v45, 0xffff0000, v45
  v_lshlrev_b32 v46, 16, v47
  v_and_b32 v47, 0xffff0000, v47
  v_mul_f32 v40, s63, v40
  v_mul_f32 v41, s63, v41
  v_mul_f32 v42, s63, v42
  v_mul_f32 v43, s63, v43
  v_mul_f32 v44, s63, v44
  v_mul_f32 v45, s63, v45
  v_mul_f32 v46, s63, v46
  v_mul_f32 v47, s63, v47
  v_cvt_pk_bf16_f32 v41, v40, v41
  v_cvt_pk_bf16_f32 v43, v42, v43
  v_cvt_pk_bf16_f32 v45, v44, v45
  v_cvt_pk_bf16_f32 v47, v46, v47
  v_lshlrev_b32 v40, 16, v41
  v_and_b32 v41, 0xffff0000, v41
  v_lshlrev_b32 v42, 16, v43
  v_and_b32 v43, 0xffff0000, v43
  v_lshlrev_b32 v44, 16, v45
  v_and_b32 v45, 0xffff0000, v45
  v_lshlrev_b32 v46, 16, v47
  v_and_b32 v47, 0xffff0000, v47
  v_max3_f32 v18, v40, v41, v42
  v_max3_f32 v18, v18, v43, v44
  v_max3_f32 v18, v18, v45, v46
  v_max_f32 v18, v18, v47
  s_nop 1
  v_max_f32_dpp v18, v18, v18 quad_perm:[1,0,3,2] row_mask:0xf bank_mask:0xf
  s_nop 1
  v_max_f32_dpp v18, v18, v18 quad_perm:[2,3,0,1] row_mask:0xf bank_mask:0xf
  s_nop 1
  v_max_f32_dpp v18, v18, v18 row_half_mirror row_mask:0xf bank_mask:0xf
  s_nop 1
  v_max_f32_dpp v18, v18, v18 row_mirror row_mask:0xf bank_mask:0xf
  v_mov_b32 v13, v18
  s_nop 1
  v_permlane16_swap_b32 v18, v13
  v_max_f32 v18, v18, v13
  v_mov_b32 v13, v18
  s_nop 1
  v_permlane32_swap_b32 v18, v13
  v_max_f32 v18, v18, v13
  v_sub_f32 v40, v40, v18
  v_sub_f32 v41, v41, v18
  v_sub_f32 v42, v42, v18
  v_sub_f32 v43, v43, v18
  v_sub_f32 v44, v44, v18
  v_sub_f32 v45, v45, v18
  v_sub_f32 v46, v46, v18
  v_sub_f32 v47, v47, v18
  v_mul_f32 v40, s62, v40
  v_mul_f32 v41, s62, v41
  v_mul_f32 v42, s62, v42
  v_mul_f32 v43, s62, v43
  v_mul_f32 v44, s62, v44
  v_mul_f32 v45, s62, v45
  v_mul_f32 v46, s62, v46
  v_mul_f32 v47, s62, v47
  v_exp_f32 v40, v40
  v_exp_f32 v41, v41
  v_exp_f32 v42, v42
  v_exp_f32 v43, v43
  v_exp_f32 v44, v44
  v_exp_f32 v45, v45
  v_exp_f32 v46, v46
  v_exp_f32 v47, v47
  v_cvt_pk_bf16_f32 v64, v40, 0
  v_cvt_pk_bf16_f32 v65, v40, 0
  v_cvt_pk_bf16_f32 v66, v40, 0
  v_cvt_pk_bf16_f32 v67, v41, 0
  v_cvt_pk_bf16_f32 v68, v41, 0
  v_cvt_pk_bf16_f32 v69, v41, 0
  v_cvt_pk_bf16_f32 v70, v42, 0
  v_cvt_pk_bf16_f32 v71, v42, 0
  v_cvt_pk_bf16_f32 v72, v42, 0
  v_cvt_pk_bf16_f32 v73, v43, 0
  v_cvt_pk_bf16_f32 v74, v43, 0
  v_cvt_pk_bf16_f32 v75, v43, 0
  v_cvt_pk_bf16_f32 v76, v44, 0
  v_cvt_pk_bf16_f32 v77, v44, 0
  v_cvt_pk_bf16_f32 v78, v44, 0
  v_cvt_pk_bf16_f32 v79, v45, 0
  v_cvt_pk_bf16_f32 v80, v45, 0
  v_cvt_pk_bf16_f32 v81, v45, 0
  v_cvt_pk_bf16_f32 v82, v46, 0
  v_cvt_pk_bf16_f32 v83, v46, 0
  v_cvt_pk_bf16_f32 v84, v46, 0
  v_cvt_pk_bf16_f32 v85, v47, 0
  v_cvt_pk_bf16_f32 v86, v47, 0
  v_cvt_pk_bf16_f32 v87, v47, 0
  ds_write_b128 v12, v[64:67] offset:0
  ds_write_b128 v12, v[68:71] offset:16
  ds_write_b128 v12, v[72:75] offset:32
  ds_write_b128 v12, v[76:79] offset:48
  ds_write_b128 v12, v[80:83] offset:64
  ds_write_b128 v12, v[84:87] offset:80
  v_add_f32 v40, v40, v44
  v_add_f32 v41, v41, v45
  v_add_f32 v42, v42, v46
  v_add_f32 v43, v43, v47
  v_add_f32 v40, v40, v41
  v_add_f32 v42, v42, v43
  v_add_f32 v61, v40, v42
  s_nop 1
  v_add_f32_dpp v61, v61, v61 quad_perm:[1,0,3,2] row_mask:0xf bank_mask:0xf
  s_nop 1
  v_add_f32_dpp v61, v61, v61 quad_perm:[2,3,0,1] row_mask:0xf bank_mask:0xf
  s_nop 1
  v_add_f32_dpp v61, v61, v61 row_half_mirror row_mask:0xf bank_mask:0xf
  s_nop 1
  v_add_f32_dpp v61, v61, v61 row_mirror row_mask:0xf bank_mask:0xf
  v_mov_b32 v13, v61
  s_nop 1
  v_permlane16_swap_b32 v61, v13
  v_add_f32 v61, v61, v13
  v_mov_b32 v13, v61
  s_nop 1
  v_permlane32_swap_b32 v61, v13
  v_add_f32 v61, v61, v13
  v_mov_b32 v60, v18
  v_mov_b32 v62, 0
  v_mov_b32 v63, 0
  v_perm_b32 v60, v60, v7, s50
  v_perm_b32 v61, v61, v7, s51
  v_perm_b32 v62, v62, v7, s52
  v_perm_b32 v63, v63, v7, s53
  v_mov_b32 v12, 1073741824
  s_cmp_eq_u32 s3, 3
  s_cselect_b32 s63, 2, 1
  v_cmp_gt_u32 vcc, s63, v0
  s_nop 1
  v_cndmask_b32 v12, v12, v6, vcc
  s_lshl_b32 s63, s31, 7
  s_add_u32 s63, s63, s82
  s_cmp_eq_u32 s84, 1
  s_cbranch_scc1 L_gs6
  buffer_store_dwordx4 v[60:63], v12, s[36:39], s63 offen sc1
  s_branch L_gt6
L_gs6:
  buffer_store_dwordx4 v[60:63], v12, s[36:39], s63 offen
L_gt6:
L_nosm:
L_nof2:
  s_cmp_eq_u32 s57, -1
  s_cbranch_scc0 L_nogate
  s_mov_b32 s44, s4
  s_mov_b32 s45, s5
  s_movk_i32 s46, 1280
  s_mov_b32 s47, 0x20000
  v_lshlrev_b32 v12, 2, v0
  s_mul_i32 s63, s3, 1280
  buffer_load_dword v64, v12, s[40:43], s63 offen offset:0
  buffer_load_dword v65, v12, s[40:43], s63 offen offset:256
  buffer_load_dword v66, v12, s[40:43], s63 offen offset:512
  buffer_load_dword v67, v12, s[40:43], s63 offen offset:768
  buffer_load_dword v68, v12, s[40:43], s63 offen offset:1024
  buffer_load_dword v72, v12, s[44:47], 0 offen offset:0
  buffer_load_dword v73, v12, s[44:47], 0 offen offset:256
  buffer_load_dword v74, v12, s[44:47], 0 offen offset:512
  buffer_load_dword v75, v12, s[44:47], 0 offen offset:768
  buffer_load_dword v76, v12, s[44:47], 0 offen offset:1024
  v_mov_b32 v16, 0
  s_waitcnt vmcnt(0)
  v_lshlrev_b32 v40, 16, v64
  v_and_b32 v41, 0xffff0000, v64
  v_lshlrev_b32 v42, 16, v72
  v_and_b32 v43, 0xffff0000, v72
  v_mul_f32 v40, v40, v42
  v_mul_f32 v41, v41, v43
  v_cvt_pk_bf16_f32 v41, v40, v41
  v_lshlrev_b32 v40, 16, v41
  v_and_b32 v41, 0xffff0000, v41
  v_add_f32 v16, v16, v40
  v_add_f32 v16, v16, v41
  v_lshlrev_b32 v40, 16, v65
  v_and_b32 v41, 0xffff0000, v65
  v_lshlrev_b32 v42, 16, v73
  v_and_b32 v43, 0xffff0000, v73
  v_mul_f32 v40, v40, v42
  v_mul_f32 v41, v41, v43
  v_cvt_pk_bf16_f32 v41, v40, v41
  v_lshlrev_b32 v40, 16, v41
  v_and_b32 v41, 0xffff0000, v41
  v_add_f32 v16, v16, v40
  v_add_f32 v16, v16, v41
  v_lshlrev_b32 v40, 16, v66
  v_and_b32 v41, 0xffff0000, v66
  v_lshlrev_b32 v42, 16, v74
  v_and_b32 v43, 0xffff0000, v74
  v_mul_f32 v40, v40, v42
  v_mul_f32 v41, v41, v43
  v_cvt_pk_bf16_f32 v41, v40, v41
  v_lshlrev_b32 v40, 16, v41
  v_and_b32 v41, 0xffff0000, v41
  v_add_f32 v16, v16, v40
  v_add_f32 v16, v16, v41
  v_lshlrev_b32 v40, 16, v67
  v_and_b32 v41, 0xffff0000, v67
  v_lshlrev_b32 v42, 16, v75
  v_and_b32 v43, 0xffff0000, v75
  v_mul_f32 v40, v40, v42
  v_mul_f32 v41, v41, v43
  v_cvt_pk_bf16_f32 v41, v40, v41
  v_lshlrev_b32 v40, 16, v41
  v_and_b32 v41, 0xffff0000, v41
  v_add_f32 v16, v16, v40
  v_add_f32 v16, v16, v41
  v_lshlrev_b32 v40, 16, v68
  v_and_b32 v41, 0xffff0000, v68
  v_lshlrev_b32 v42, 16, v76
  v_and_b32 v43, 0xffff0000, v76
  v_mul_f32 v40, v40, v42
  v_mul_f32 v41, v41, v43
  v_cvt_pk_bf16_f32 v41, v40, v41
  v_lshlrev_b32 v40, 16, v41
  v_and_b32 v41, 0xffff0000, v41
  v_add_f32 v16, v16, v40
  v_add_f32 v16, v16, v41
  s_nop 1
  v_add_f32_dpp v16, v16, v16 quad_perm:[1,0,3,2] row_mask:0xf bank_mask:0xf
  s_nop 1
  v_add_f32_dpp v16, v16, v16 quad_perm:[2,3,0,1] row_mask:0xf bank_mask:0xf
  s_nop 1
  v_add_f32_dpp v16, v16, v16 row_half_mirror row_mask:0xf bank_mask:0xf
  s_nop 1
  v_add_f32_dpp v16, v16, v16 row_mirror row_mask:0xf bank_mask:0xf
  v_mov_b32 v13, v16
  s_nop 1
  v_permlane16_swap_b32 v16, v13
  v_add_f32 v16, v16, v13
  v_mov_b32 v13, v16
  s_nop 1
  v_permlane32_swap_b32 v16, v13
  v_add_f32 v16, v16, v13
  v_cvt_pk_bf16_f32 v16, v16, v16
  v_and_b32 v16, 0xffff0000, v16
  v_mul_f32 v16, 0xbfb8aa3b, v16
  v_exp_f32 v16, v16
  s_nop 0
  v_add_f32 v16, 1.0, v16
  v_rcp_f32 v16, v16
  s_nop 0
  v_cvt_pk_bf16_f32 v16, v16, v16
  v_and_b32 v16, 0xffff0000, v16
  v_sub_f32 v17, 1.0, v16
  v_cvt_pk_bf16_f32 v17, v17, v17
  v_and_b32 v17, 0xffff0000, v17
L_nogate:
  s_cmp_eq_u32 s57, 1
  s_cbranch_scc0 L_noffn
  v_mov_b32 v40, 0
  s_cmp_lt_u32 s30, 24
  s_cbranch_scc0 L_ffnw
  s_add_u32 s63, s80, 6144
  s_mov_b32 s71, 200000
L_pf:
  s_cmp_gt_u32 s71, s81
  s_cbranch_scc1 L_pl7
  buffer_load_dwordx4 v[104:107], v6, s[36:39], s63 offen sc1
  buffer_load_dwordx4 v[108:111], v6, s[36:39], s63 offen offset:1024 sc1
  s_branch L_pm7
L_pl7:
  buffer_load_dwordx4 v[104:107], v6, s[36:39], s63 offen nt
  buffer_load_dwordx4 v[108:111], v6, s[36:39], s63 offen offset:1024 nt
L_pm7:
L_pf_c:
  s_waitcnt vmcnt(0)
  v_perm_b32 v112, v105, v104, s54
  v_perm_b32 v113, v107, v106, s55
  v_perm_b32 v114, v109, v108, s54
  v_perm_b32 v115, v111, v110, s55
  v_bitop3_b32 v112, v112, v113, v7 bitop3:0x56
  v_bitop3_b32 v114, v114, v115, v7 bitop3:0x56
  v_or_b32 v112, v112, v114
  v_cmp_ne_u32 vcc, 0, v112
  s_sub_u32 s71, s71, 1
  s_cbranch_scc1 L_pf_x
  s_and_b64 exec, exec, vcc
  s_cbranch_scc1 L_pf
L_pf_x:
  s_mov_b64 exec, -1
  v_and_b32 v104, s56, v104
  v_and_b32 v105, s56, v105
  v_and_b32 v106, s56, v106
  v_and_b32 v107, s56, v107
  v_and_b32 v108, s56, v108
  v_and_b32 v109, s56, v109
  v_and_b32 v110, s56, v110
  v_and_b32 v111, s56, v111
  s_cmp_eq_u32 s3, 1
  s_cselect_b64 vcc, -1, 0
  v_cndmask_b32 v104, v104, v105, vcc
  v_cndmask_b32 v108, v108, v109, vcc
  s_cmp_eq_u32 s3, 2
  s_cselect_b64 vcc, -1, 0
  v_cndmask_b32 v104, v104, v106, vcc
  v_cndmask_b32 v108, v108, v110, vcc
  s_cmp_eq_u32 s3, 3
  s_cselect_b64 vcc, -1, 0
  v_cndmask_b32 v104, v104, v107, vcc
  v_cndmask_b32 v108, v108, v111, vcc
  v_cvt_pk_bf16_f32 v104, v104, v104
  v_and_b32 v104, 0xffff0000, v104
  v_cvt_pk_bf16_f32 v108, v108, v108
  v_and_b32 v108, 0xffff0000, v108
  v_mul_f32 v40, v104, v104
  v_mul_f32 v40, 0x3d372713, v40
  v_add_f32 v40, 1.0, v40
  v_mul_f32 v40, v40, v104
  v_mul_f32 v40, 0xc0135761, v40
  v_exp_f32 v40, v40
  s_nop 0
  v_add_f32 v40, 1.0, v40
  v_rcp_f32 v40, v40
  s_nop 0
  v_mul_f32 v40, v40, v104
  v_cvt_pk_bf16_f32 v40, v40, v40
  v_and_b32 v40, 0xffff0000, v40
  v_mul_f32 v40, v40, v108
  v_cvt_pk_bf16_f32 v40, v40, v40
  v_and_b32 v40, 0xffff0000, v40
  v_mul_f32 v40, v40, v17
  v_cvt_pk_bf16_f32 v40, v40, v40
L_ffnw:
  s_mul_i32 s63, s3, 576
  s_add_u32 s63, s63, 124800
  v_lshl_add_u32 v12, v0, 1, s63
  ds_write_b16 v12, v40
L_noffn:
  s_add_u32 s63, s3, 3
  s_cmp_eq_u32 s57, s63
  s_cbranch_scc0 L_nomg
  s_cmp_eq_u32 s3, 0
  s_cselect_b32 s63, 64, -16
  s_add_u32 s63, s63, s82
  s_mov_b32 s71, 200000
L_pm:
  s_cmp_gt_u32 s71, s81
  s_cbranch_scc1 L_pl8
  buffer_load_dwordx4 v[104:107], v36, s[36:39], s82 offen sc1
  buffer_load_dwordx4 v[108:111], v36, s[36:39], s63 offen offset:0 sc1
  s_branch L_pm8
L_pl8:
  buffer_load_dwordx4 v[104:107], v36, s[36:39], s82 offen nt
  buffer_load_dwordx4 v[108:111], v36, s[36:39], s63 offen offset:0 nt
L_pm8:
L_pm_c:
  s_waitcnt vmcnt(0)
  v_perm_b32 v112, v105, v104, s54
  v_perm_b32 v113, v107, v106, s55
  v_perm_b32 v114, v109, v108, s54
  v_perm_b32 v115, v111, v110, s55
  v_bitop3_b32 v112, v112, v113, v7 bitop3:0x56
  v_bitop3_b32 v114, v114, v115, v7 bitop3:0x56
  v_or_b32 v112, v112, v114
  v_cmp_ne_u32 vcc, 0, v112
  s_sub_u32 s71, s71, 1
  s_cbranch_scc1 L_pm_x
  s_and_b64 exec, exec, vcc
  s_cbranch_scc1 L_pm
L_pm_x:
  s_mov_b64 exec, -1
  v_and_b32 v104, s56, v104
  v_and_b32 v105, s56, v105
  v_and_b32 v106, s56, v106
  v_and_b32 v107, s56, v107
  v_and_b32 v108, s56, v108
  v_and_b32 v109, s56, v109
  v_and_b32 v110, s56, v110
  v_and_b32 v111, s56, v111
  v_mov_b32 v40, v104
  s_nop 1
  v_max_f32_dpp v40, v40, v40 quad_perm:[1,0,3,2] row_mask:0xf bank_mask:0xf
  s_nop 1
  v_max_f32_dpp v40, v40, v40 quad_perm:[2,3,0,1] row_mask:0xf bank_mask:0xf
  s_nop 1
  v_max_f32_dpp v40, v40, v40 row_half_mirror row_mask:0xf bank_mask:0xf
  v_sub_f32 v41, v104, v40
  v_sub_f32 v42, v18, v40
  v_mul_f32 v41, 0x3fb8aa3b, v41
  v_mul_f32 v42, 0x3fb8aa3b, v42
  v_exp_f32 v41, v41
  v_exp_f32 v42, v42
  v_mul_f32 v41, v41, v105
  s_nop 1
  v_add_f32_dpp v41, v41, v41 quad_perm:[1,0,3,2] row_mask:0xf bank_mask:0xf
  s_nop 1
  v_add_f32_dpp v41, v41, v41 quad_perm:[2,3,0,1] row_mask:0xf bank_mask:0xf
  s_nop 1
  v_add_f32_dpp v41, v41, v41 row_half_mirror row_mask:0xf bank_mask:0xf
  v_rcp_f32 v41, v41
  v_mul_f32 v42, v42, v16
  v_mul_f32 v42, v42, v41
  ds_write_b32 v39, v42
L_nomg:
  s_cmp_eq_u32 s57, 6
  s_cbranch_scc0 L_nosw
  s_mov_b32 s83, s93
  v_mov_b32 v21, v143
  s_mov_b32 s92, 7
  v_mov_b32 v39, 126748
  v_xor_b32 v141, 0x80808080, v7
  s_mul_i32 s87, s31, 1024
  s_add_u32 s87, s87, s93
  s_mul_i32 s63, s3, 192
  s_add_u32 s63, s63, 115712
  v_add_u32 v22, s63, v6
  v_mov_b32 v12, 1073741824
  v_cmp_gt_u32 vcc, 12, v0
  s_nop 1
  v_cndmask_b32 v23, v12, v6, vcc
L_nosw:
  s_add_u32 s63, s57, 2
  s_and_b32 s62, s63, 3
  s_cmp_eq_u32 s62, s3
  s_cbranch_scc0 L_c1_x
  s_mul_i32 s63, s63, 24
  s_add_u32 s63, s63, -2
  s_min_u32 s63, s63, 186
  s_movk_i32 s71, 64
L_c1:
  buffer_load_dwordx2 v[104:105], v139, s[36:39], s95 offen nt
  v_mov_b32 v107, 0
  s_cmp_ge_i32 s57, 4
  s_cbranch_scc0 L_c1_nd
  buffer_load_dwordx2 v[106:107], v187, s[36:39], 0 offen nt
L_c1_nd:
  s_mov_b32 s61, 0x10000
  s_movk_i32 s62, 0x100
  s_waitcnt vmcnt(0)
  v_sub_u32 v40, v104, v184
  v_sub_u32 v41, v105, v185
  v_add_u32 v42, s61, v40
  v_add_u32 v43, s61, v41
  v_cmp_gt_u32 vcc, s62, v40
  s_nop 1
  v_cndmask_b32 v42, 0, v42, vcc
  v_cmp_gt_u32 vcc, s62, v41
  s_nop 1
  v_cndmask_b32 v43, 0, v43, vcc
  v_add_u32 v42, v42, v43
  s_nop 1
  v_add_u32_dpp v42, v42, v42 quad_perm:[1,0,3,2] row_mask:0xf bank_mask:0xf
  s_nop 1
  v_add_u32_dpp v42, v42, v42 quad_perm:[2,3,0,1] row_mask:0xf bank_mask:0xf
  s_nop 1
  v_add_u32_dpp v42, v42, v42 row_half_mirror row_mask:0xf bank_mask:0xf
  s_nop 1
  v_add_u32_dpp v42, v42, v42 row_mirror row_mask:0xf bank_mask:0xf
  v_mov_b32 v13, v42
  s_nop 1
  v_permlane16_swap_b32 v42, v13
  v_add_u32 v42, v42, v13
  v_mov_b32 v13, v42
  s_nop 1
  v_permlane32_swap_b32 v42, v13
  v_add_u32 v42, v42, v13
  v_lshrrev_b32 v43, 16, v42
  v_and_b32 v42, 0xffff, v42
  v_cvt_f32_u32 v43, v43
  v_cvt_f32_u32 v42, v42
  v_rcp_f32 v43, v43
  v_cvt_f32_u32 v48, v40
  v_cvt_f32_u32 v49, v41
  v_mul_f32 v42, v42, v43
  v_cmp_eq_u32 vcc, v107, v7
  s_nop 1
  v_cndmask_b32 v50, 0, v106, vcc
  v_add_f32 v42, v42, v50
  v_add_f32 v42, s85, v42
  v_cmp_gt_u32 vcc, s62, v40
  v_sub_f32 v48, v42, v48
  s_nop 0
  v_cndmask_b32 v48, 0, v48, vcc
  v_mul_f32 v50, 0x40600000, v48
  v_mul_f32 v51, 0xc0000000, v48
  v_add_f32 v50, 0x40133333, v50
  v_add_f32 v51, 0x40266666, v51
  v_cvt_u32_f32 v50, v50
  v_cvt_u32_f32 v51, v51
  v_min_u32 v50, 32, v50
  v_min_u32 v51, 32, v51
  v_add_u32 v52, v50, v104
  v_add_u32 v53, v51, v104
  v_cmp_le_u32 vcc, 3, v50
  s_nop 1
  v_cndmask_b32 v44, 0, v52, vcc
  v_cmp_le_u32 vcc, 3, v51
  s_nop 1
  v_cndmask_b32 v45, 0, v53, vcc
  v_cmp_gt_u32 vcc, s62, v41
  v_sub_f32 v49, v42, v49
  s_nop 0
  v_cndmask_b32 v49, 0, v49, vcc
  v_mul_f32 v50, 0x40600000, v49
  v_mul_f32 v51, 0xc0000000, v49
  v_add_f32 v50, 0x40133333, v50
  v_add_f32 v51, 0x40266666, v51
  v_cvt_u32_f32 v50, v50
  v_cvt_u32_f32 v51, v51
  v_min_u32 v50, 32, v50
  v_min_u32 v51, 32, v51
  v_add_u32 v52, v50, v105
  v_add_u32 v53, v51, v105
  v_cmp_le_u32 vcc, 3, v50
  s_nop 1
  v_cndmask_b32 v46, 0, v52, vcc
  v_cmp_le_u32 vcc, 3, v51
  s_nop 1
  v_cndmask_b32 v47, 0, v53, vcc
  v_max_u32 v40, v40, v41
  ds_write_b128 v140, v[44:47]
  v_cmp_gt_u32 vcc, s62, v40
  s_nop 1
  v_cndmask_b32 v40, 0, v40, vcc
  s_andn2_b64 s[44:45], s[100:101], vcc
  s_cselect_b32 s84, s84, 1
  v_mov_b32 v13, 126720
  v_mov_b32 v14, s84
  ds_write_b32 v13, v14 offset:4
  v_readlane_b32 s61, v40, s60
  s_sub_u32 s71, s71, 1
  s_cbranch_scc1 L_c1_x
  s_cmp_lt_u32 s61, s63
  s_cbranch_scc1 L_c1
L_c1_x:
  s_add_u32 s57, s57, 1
  s_waitcnt lgkmcnt(0)
  s_cmp_eq_u32 s57, 7
  s_cbranch_scc1 L_tail
  s_branch L_hloop
  s_endpgm
  s_endpgm
  s_endpgm
  s_endpgm
  s_endpgm
  s_endpgm
  s_endpgm
  s_endpgm
  s_endpgm
  s_endpgm
  s_endpgm
  s_endpgm
  s_endpgm
  s_endpgm
  s_endpgm
  s_endpgm
  s_endpgm
  s_endpgm
  s_endpgm
  s_endpgm
  s_endpgm
  s_endpgm
  s_endpgm
  s_endpgm
  s_endpgm
  s_endpgm
  s_endpgm
  s_endpgm
  s_endpgm
  s_endpgm
  s_endpgm
  s_endpgm
  s_endpgm
  s_endpgm
  s_endpgm
  s_endpgm
  s_endpgm
  s_endpgm
  s_endpgm
  s_endpgm
  s_endpgm
  s_endpgm
  s_endpgm
  s_endpgm
  s_endpgm
  s_endpgm
  s_endpgm
  s_endpgm
  s_endpgm
  s_endpgm
  s_endpgm
  s_endpgm
  s_endpgm
  s_endpgm
  s_endpgm
  s_endpgm
  s_endpgm
  s_endpgm
  s_endpgm
  s_endpgm
  s_endpgm
  s_endpgm
  s_endpgm
  s_endpgm
.section .rodata,"a"
.p2align 6
.amdhsa_kernel gated_mix__mha_block_cached__geglu_ffn__decode_kernel
  .amdhsa_next_free_vgpr 256
  .amdhsa_next_free_sgpr 102
  .amdhsa_accum_offset 256
  .amdhsa_group_segment_fixed_size 0
  .amdhsa_kernarg_size 104
  .amdhsa_user_sgpr_count 2
  .amdhsa_user_sgpr_kernarg_segment_ptr 1
  .amdhsa_system_sgpr_workgroup_id_x 1
  .amdhsa_float_denorm_mode_32 3
.end_amdhsa_kernel
```
